```python
import torch

def _softmax(x, axis=-1):
    return torch.softmax(x, dim=axis)
def _gelu(x):
    return torch.nn.functional.gelu(x, approximate="tanh")
def _silu(x):
    return torch.nn.functional.silu(x)
def _sigmoid(x):
    return torch.sigmoid(x)
def _layernorm(x, axis=-1, eps=1e-5):
    m = x.mean(dim=axis, keepdim=True)
    v = x.var(dim=axis, keepdim=True, unbiased=False)
    return (x - m) / torch.sqrt(v + eps)
def _scatter_add(tgt, idx, src, axis=0):
    return tgt.clone().index_add_(axis, idx, src)
def _segment_sum(src, seg, n):
    out = torch.zeros((n,) + src.shape[1:], dtype=src.dtype)
    return out.index_add_(0, seg, src)
def _pad(x, pw):
    flat = tuple(v for pair in reversed(pw) for v in pair)
    return torch.nn.functional.pad(x, flat)

kernel_name = 'recurrent_scan__sliding_block_cached__dense_activation_relu__decode'

def setup_inputs():

    _w = (lambda a: (lambda t: t.to(torch.bfloat16) if t.is_floating_point() else t)(torch.as_tensor(a)))
    def _A_setup():
        B, Sq, D = 4, 1, 512
        Hq, Hkv, Sk, Dh = 32, 8, 16384, 128
        assert Hq % Hkv == 0, (Hq, Hkv)
        return {
            "x": _w((lambda *s: torch.randn(*s, dtype=torch.bfloat16) * 0.05)(B, Sq, D)),
            "k_cache": _w((lambda *s: torch.randn(*s, dtype=torch.bfloat16) * 1.6)(B, Hkv, Sk, Dh)),
            "v_cache": _w((lambda *s: torch.randn(*s, dtype=torch.bfloat16) * 0.2)(B, Hkv, Sk, Dh)),
            "wq": _w((lambda *s: torch.randn(*s, dtype=torch.bfloat16) * 1.6)(D, Hq * Dh) * (D ** -0.5)),
            "wo": _w((lambda *s: torch.randn(*s, dtype=torch.bfloat16) * 0.2)(Hq * Dh, D) * ((Hq * Dh) ** -0.5)),
        }
    _A_in = _A_setup()

    def _B_setup():
        B, S, D, Dff = 4, 1, 512, 1792
        return {
            "x": _w((lambda *s: torch.randn(*s, dtype=torch.bfloat16) * 0.05)(B, S, D)),
            "w1": _w((lambda *s: torch.randn(*s, dtype=torch.bfloat16) * 0.1)(D, Dff)),
            "w2": _w((lambda *s: torch.randn(*s, dtype=torch.bfloat16) * 0.1)(Dff, D)),
        }
    _B_in = _B_setup()

    return {
        "A_x": _A_in["x"],
        "A_k_cache": _A_in["k_cache"],
        "A_v_cache": _A_in["v_cache"],
        "A_wq": _A_in["wq"],
        "A_wo": _A_in["wo"],
        "B_x": _B_in["x"],
        "B_w1": _B_in["w1"],
        "B_w2": _B_in["w2"],
    }

def reference(A_x, A_k_cache, A_v_cache, A_wq, A_wo, B_x, B_w1, B_w2):
    def _A_ref(x, k_cache, v_cache, wq, wo):
        B, Sq, D = x.shape
        Hq, Dh = 32, 128
        Hkv, Sk = k_cache.shape[1], k_cache.shape[2]
        W = min(4096, max(256, Sk // 4))
        rep = Hq // Hkv
        q = (lambda x, *d: x.permute(*d))((x @ wq).reshape(B, Sq, Hq, Dh), 0, 2, 1, 3)
        k = (lambda x, n, axis: torch.repeat_interleave(x, n, dim=axis))(k_cache[:, :, Sk - W:, :], rep, axis=1)
        v = (lambda x, n, axis: torch.repeat_interleave(x, n, dim=axis))(v_cache[:, :, Sk - W:, :], rep, axis=1)
        scores = torch.einsum("bhqd,bhkd->bhqk", q, k) * (Dh ** -0.5)
        p = _softmax(scores, axis=-1)
        o = torch.einsum("bhqk,bhkd->bhqd", p, v)
        return (lambda x, *d: x.permute(*d))(o, 0, 2, 1, 3).reshape(B, Sq, Hq * Dh) @ wo

    def _B_ref(x, w1, w2):
        h = torch.einsum("bsd,df->bsf", x, w1)
        zero = torch.zeros_like(h)
        h = torch.maximum(h, zero)
        return torch.einsum("bsf,fd->bsd", h, w2)

    x = A_x
    xn = _layernorm(x, axis=-1)
    s = _A_ref(xn, A_k_cache, A_v_cache, A_wq, A_wo)
    g = _silu(_B_ref(xn, B_w1, B_w2))
    return x + s * g
```

```asm
; @launch grid=(256,1,1) block=(1024,1,1) lds=163840
.amdgcn_target "amdgcn-amd-amdhsa--gfx950"
.text
.globl recurrent_scan__sliding_block_cached__dense_activation_relu__decode_kernel
.p2align 8
.type recurrent_scan__sliding_block_cached__dense_activation_relu__decode_kernel,@function
recurrent_scan__sliding_block_cached__dense_activation_relu__decode_kernel:
    s_cmp_ge_u32 s2, 256
    s_cbranch_scc1 L_exit
    s_load_dwordx16 s[16:31], s[0:1], 0
    s_load_dwordx4 s[32:35], s[0:1], 64
    s_load_dwordx2 s[36:37], s[0:1], 80
    v_lshrrev_b32 v1, 6, v0
    v_and_b32 v0, 63, v0
    v_readfirstlane_b32 s3, v1
    s_and_b32 s4, s2, 7
    s_lshr_b32 s5, s2, 3
    s_lshr_b32 s6, s5, 3
    s_and_b32 s7, s5, 7
    s_mul_i32 s8, s2, 0x9e3779b1
    s_lshr_b32 s8, s8, 26
    v_mov_b32 v2, 161408
    v_mov_b32 v1, 1
    s_mov_b32 s58, 4294966272
    s_cmp_eq_u32 s3, 12
    s_cbranch_scc0 Lc_1
    v_lshl_add_u32 v14, v0, 2, v2
    v_mov_b32 v15, 0
    ds_write_b32 v14, v15
    s_getpc_b64 s[10:11]
L_pc_here:
    s_sub_u32 s10, s10, L_pc_here-recurrent_scan__sliding_block_cached__dense_activation_relu__decode_kernel
    s_subb_u32 s11, s11, 0
    s_lshl_b32 s9, s5, 10
    v_lshl_add_u32 v16, v0, 4, s9
    s_cmp_lt_u32 s5, (L_code_end-recurrent_scan__sliding_block_cached__dense_activation_relu__decode_kernel)/1024
    s_nop 0
    s_cbranch_scc0 Lp_2
    global_load_dwordx4 v[20:23], v16, s[10:11]
Lp_2:
    s_waitcnt lgkmcnt(0)
Lc_1:
    s_cmp_lt_u32 s3, 4
    s_cbranch_scc1 L_aux
    s_cmp_ge_u32 s3, 12
    s_cbranch_scc1 L_loader
L_kw:
    s_setprio 1
    s_sub_u32 s12, s3, 4
    s_lshl_b32 s9, s6, 3
    s_add_u32 s9, s9, s4
    s_lshl_b32 s9, s9, 22
    s_lshl_b32 s10, s7, 17
    s_add_u32 s9, s9, s10
    s_add_u32 s9, s9, 3145728
    v_and_b32 v4, 15, v0
    v_lshrrev_b32 v5, 4, v0
    v_lshrrev_b32 v6, 1, v4
    v_lshlrev_b32 v6, 8, v6
    v_and_b32 v7, 1, v4
    v_lshl_add_u32 v6, v7, 6, v6
    v_lshl_add_u32 v3, v5, 4, v6
    s_lshl_b32 s13, s12, 3
    s_add_u32 s13, s13, s8
    s_mov_b32 s42, 131072
    s_mov_b32 s43, 0x20000
    s_barrier
    s_waitcnt lgkmcnt(0)
    s_add_u32 s40, s18, s9
    s_addc_u32 s41, s19, 0
    s_add_u32 s10, s13, 0
    s_and_b32 s10, s10, 63
    s_lshl_b32 s10, s10, 11
    buffer_load_dwordx4 v[64:67], v3, s[40:43], s10 offen offset:0 nt
    buffer_load_dwordx4 v[68:71], v3, s[40:43], s10 offen offset:128 nt
    s_add_u32 s10, s13, 1
    s_and_b32 s10, s10, 63
    s_lshl_b32 s10, s10, 11
    buffer_load_dwordx4 v[72:75], v3, s[40:43], s10 offen offset:0 nt
    buffer_load_dwordx4 v[76:79], v3, s[40:43], s10 offen offset:128 nt
    s_add_u32 s10, s13, 2
    s_and_b32 s10, s10, 63
    s_lshl_b32 s10, s10, 11
    buffer_load_dwordx4 v[80:83], v3, s[40:43], s10 offen offset:0 nt
    buffer_load_dwordx4 v[84:87], v3, s[40:43], s10 offen offset:128 nt
    s_add_u32 s10, s13, 3
    s_and_b32 s10, s10, 63
    s_lshl_b32 s10, s10, 11
    buffer_load_dwordx4 v[88:91], v3, s[40:43], s10 offen offset:0 nt
    s_waitcnt vmcnt(6)
    buffer_load_dwordx4 v[92:95], v3, s[40:43], s10 offen offset:128 nt
    s_waitcnt vmcnt(6)
    s_add_u32 s10, s13, 4
    s_and_b32 s10, s10, 63
    s_lshl_b32 s10, s10, 11
    buffer_load_dwordx4 v[96:99], v3, s[40:43], s10 offen offset:0 nt
    s_waitcnt vmcnt(6)
    buffer_load_dwordx4 v[100:103], v3, s[40:43], s10 offen offset:128 nt
    s_waitcnt vmcnt(6)
    s_add_u32 s10, s13, 5
    s_and_b32 s10, s10, 63
    s_lshl_b32 s10, s10, 11
    buffer_load_dwordx4 v[104:107], v3, s[40:43], s10 offen offset:0 nt
    s_waitcnt vmcnt(6)
    buffer_load_dwordx4 v[108:111], v3, s[40:43], s10 offen offset:128 nt
    s_waitcnt vmcnt(6)
    s_cmp_eq_u32 s12, 7
    s_cbranch_scc0 Lk_3
    s_mov_b64 exec, 1
    ds_write_b32 v2, v1 offset:12
    s_mov_b64 exec, -1
Lk_3:
    s_add_u32 s10, s13, 6
    s_and_b32 s10, s10, 63
    s_lshl_b32 s10, s10, 11
    buffer_load_dwordx4 v[112:115], v3, s[40:43], s10 offen offset:0 nt
    s_waitcnt vmcnt(6)
    buffer_load_dwordx4 v[116:119], v3, s[40:43], s10 offen offset:128 nt
    s_waitcnt vmcnt(6)
    s_add_u32 s10, s13, 7
    s_and_b32 s10, s10, 63
    s_lshl_b32 s10, s10, 11
    buffer_load_dwordx4 v[120:123], v3, s[40:43], s10 offen offset:0 nt
    s_waitcnt vmcnt(6)
    buffer_load_dwordx4 v[124:127], v3, s[40:43], s10 offen offset:128 nt
    s_mov_b64 exec, 1
    ds_add_u32 v2, v1 offset:8
    s_mov_b64 exec, -1
    s_mov_b32 s52, s36
    s_mov_b32 s53, s37
    s_mov_b32 s54, 3145728
    s_mov_b32 s55, 0x20000
    v_lshrrev_b32 v6, 1, v4
    v_and_b32 v6, 3, v6
    v_lshlrev_b32 v8, 8, v6
    v_lshl_add_u32 v8, v7, 6, v8
    v_lshl_add_u32 v8, v5, 4, v8
    v_add_u32 v8, 160000, v8
    s_mov_b32 s56, 0xaaaaaaaa
    s_mov_b32 s57, 0xaaaaaaaa
    s_mov_b32 s60, 0
    s_mov_b64 exec, 1
Lw_4:
    ds_read_b32 v24, v2 offset:16
    s_waitcnt lgkmcnt(0)
    v_readfirstlane_b32 s62, v24
    s_cmp_ge_u32 s62, 1
    s_cbranch_scc1 Ld_5
    s_sleep 4
    s_add_u32 s60, s60, 1
    s_cmp_lt_u32 s60, 4194304
    s_cbranch_scc1 Lw_4
    s_mov_b32 s61, 257
    s_branch L_fail
Ld_5:
    s_mov_b64 exec, -1
    ds_read_b128 v[12:15], v8 offset:128
    ds_read_b128 v[8:11], v8
    s_waitcnt lgkmcnt(0)
    s_waitcnt vmcnt(14)
    v_mfma_f32_16x16x32_bf16 v[32:35], v[64:67], v[8:11], 0
    v_mfma_f32_16x16x32_bf16 v[32:35], v[68:71], v[12:15], v[32:35]
    s_waitcnt vmcnt(12)
    v_mfma_f32_16x16x32_bf16 v[36:39], v[72:75], v[8:11], 0
    v_mfma_f32_16x16x32_bf16 v[36:39], v[76:79], v[12:15], v[36:39]
    s_waitcnt vmcnt(10)
    v_mfma_f32_16x16x32_bf16 v[40:43], v[80:83], v[8:11], 0
    v_mfma_f32_16x16x32_bf16 v[40:43], v[84:87], v[12:15], v[40:43]
    s_waitcnt vmcnt(8)
    v_mfma_f32_16x16x32_bf16 v[44:47], v[88:91], v[8:11], 0
    v_mfma_f32_16x16x32_bf16 v[44:47], v[92:95], v[12:15], v[44:47]
    s_waitcnt vmcnt(6)
    v_mfma_f32_16x16x32_bf16 v[48:51], v[96:99], v[8:11], 0
    v_mfma_f32_16x16x32_bf16 v[48:51], v[100:103], v[12:15], v[48:51]
    s_waitcnt vmcnt(4)
    v_mfma_f32_16x16x32_bf16 v[52:55], v[104:107], v[8:11], 0
    v_mfma_f32_16x16x32_bf16 v[52:55], v[108:111], v[12:15], v[52:55]
    s_waitcnt vmcnt(2)
    v_mfma_f32_16x16x32_bf16 v[56:59], v[112:115], v[8:11], 0
    v_mfma_f32_16x16x32_bf16 v[56:59], v[116:119], v[12:15], v[56:59]
    s_waitcnt vmcnt(0)
    v_mfma_f32_16x16x32_bf16 v[60:63], v[120:123], v[8:11], 0
    v_mfma_f32_16x16x32_bf16 v[60:63], v[124:127], v[12:15], v[60:63]
    v_add_f32_dpp v24, v33, v32 quad_perm:[1,0,3,2] row_mask:0xf bank_mask:0xf
    v_add_f32_dpp v25, v34, v35 quad_perm:[1,0,3,2] row_mask:0xf bank_mask:0xf
    v_cndmask_b32 v16, v24, v25, s[56:57]
    v_add_f32_dpp v24, v37, v36 quad_perm:[1,0,3,2] row_mask:0xf bank_mask:0xf
    v_add_f32_dpp v25, v38, v39 quad_perm:[1,0,3,2] row_mask:0xf bank_mask:0xf
    v_cndmask_b32 v17, v24, v25, s[56:57]
    v_add_f32_dpp v24, v41, v40 quad_perm:[1,0,3,2] row_mask:0xf bank_mask:0xf
    v_add_f32_dpp v25, v42, v43 quad_perm:[1,0,3,2] row_mask:0xf bank_mask:0xf
    v_cndmask_b32 v18, v24, v25, s[56:57]
    v_add_f32_dpp v24, v45, v44 quad_perm:[1,0,3,2] row_mask:0xf bank_mask:0xf
    v_add_f32_dpp v25, v46, v47 quad_perm:[1,0,3,2] row_mask:0xf bank_mask:0xf
    v_cndmask_b32 v19, v24, v25, s[56:57]
    v_add_f32_dpp v24, v49, v48 quad_perm:[1,0,3,2] row_mask:0xf bank_mask:0xf
    v_add_f32_dpp v25, v50, v51 quad_perm:[1,0,3,2] row_mask:0xf bank_mask:0xf
    v_cndmask_b32 v20, v24, v25, s[56:57]
    v_add_f32_dpp v24, v53, v52 quad_perm:[1,0,3,2] row_mask:0xf bank_mask:0xf
    v_add_f32_dpp v25, v54, v55 quad_perm:[1,0,3,2] row_mask:0xf bank_mask:0xf
    v_cndmask_b32 v21, v24, v25, s[56:57]
    v_add_f32_dpp v24, v57, v56 quad_perm:[1,0,3,2] row_mask:0xf bank_mask:0xf
    v_add_f32_dpp v25, v58, v59 quad_perm:[1,0,3,2] row_mask:0xf bank_mask:0xf
    v_cndmask_b32 v22, v24, v25, s[56:57]
    v_add_f32_dpp v24, v61, v60 quad_perm:[1,0,3,2] row_mask:0xf bank_mask:0xf
    v_add_f32_dpp v25, v62, v63 quad_perm:[1,0,3,2] row_mask:0xf bank_mask:0xf
    v_cndmask_b32 v23, v24, v25, s[56:57]
    v_cvt_pk_bf16_f32 v24, v16, v17
    v_lshlrev_b32 v16, 16, v24
    v_and_b32 v17, 0xffff0000, v24
    v_mul_f32 v16, 0x3db504f3, v16
    v_mul_f32 v17, 0x3db504f3, v17
    v_cvt_pk_bf16_f32 v24, v16, v17
    v_lshlrev_b32 v16, 16, v24
    v_and_b32 v17, 0xffff0000, v24
    v_cvt_pk_bf16_f32 v24, v18, v19
    v_lshlrev_b32 v18, 16, v24
    v_and_b32 v19, 0xffff0000, v24
    v_mul_f32 v18, 0x3db504f3, v18
    v_mul_f32 v19, 0x3db504f3, v19
    v_cvt_pk_bf16_f32 v24, v18, v19
    v_lshlrev_b32 v18, 16, v24
    v_and_b32 v19, 0xffff0000, v24
    v_cvt_pk_bf16_f32 v24, v20, v21
    v_lshlrev_b32 v20, 16, v24
    v_and_b32 v21, 0xffff0000, v24
    v_mul_f32 v20, 0x3db504f3, v20
    v_mul_f32 v21, 0x3db504f3, v21
    v_cvt_pk_bf16_f32 v24, v20, v21
    v_lshlrev_b32 v20, 16, v24
    v_and_b32 v21, 0xffff0000, v24
    v_cvt_pk_bf16_f32 v24, v22, v23
    v_lshlrev_b32 v22, 16, v24
    v_and_b32 v23, 0xffff0000, v24
    v_mul_f32 v22, 0x3db504f3, v22
    v_mul_f32 v23, 0x3db504f3, v23
    v_cvt_pk_bf16_f32 v24, v22, v23
    v_lshlrev_b32 v22, 16, v24
    v_and_b32 v23, 0xffff0000, v24
    v_max3_f32 v24, v16, v17, v18
    v_max3_f32 v24, v24, v19, v20
    v_max3_f32 v24, v24, v21, v22
    v_max_f32 v24, v24, v23
    s_nop 1
    v_max_f32_dpp v24, v24, v24 quad_perm:[1,0,3,2] row_mask:0xf bank_mask:0xf
    v_mov_b32 v25, v24
    s_nop 1
    v_permlane16_swap_b32 v24, v25
    v_max_f32 v24, v24, v25
    v_mov_b32 v25, v24
    s_nop 1
    v_permlane32_swap_b32 v24, v25
    v_max_f32 v24, v24, v25
    v_lshlrev_b32 v26, 5, v6
    s_lshl_b32 s9, s12, 2
    s_add_u32 s9, s9, 161024
    v_add_u32 v27, s9, v26
    ds_write_b32 v27, v24
    s_mov_b64 exec, 1
    ds_add_u32 v2, v1 offset:20
    s_mov_b64 exec, -1
    s_mov_b32 s60, 0
    s_mov_b64 exec, 1
Lw_6:
    ds_read_b32 v25, v2 offset:20
    s_waitcnt lgkmcnt(0)
    v_readfirstlane_b32 s62, v25
    s_cmp_ge_u32 s62, 8
    s_cbranch_scc1 Ld_7
    s_add_u32 s60, s60, 1
    s_cmp_lt_u32 s60, 4194304
    s_nop 0
    s_cbranch_scc1 Lw_6
    s_mov_b32 s61, 258
    s_branch L_fail
Ld_7:
    s_mov_b64 exec, -1
    v_add_u32 v28, 161024, v26
    ds_read_b128 v[32:35], v28
    ds_read_b128 v[36:39], v28 offset:16
    s_waitcnt lgkmcnt(0)
    v_max3_f32 v24, v32, v33, v34
    v_max3_f32 v24, v24, v35, v36
    v_max3_f32 v24, v24, v37, v38
    v_max_f32 v24, v24, v39
    v_sub_f32 v16, v16, v24
    v_sub_f32 v17, v17, v24
    v_sub_f32 v18, v18, v24
    v_sub_f32 v19, v19, v24
    v_sub_f32 v20, v20, v24
    v_sub_f32 v21, v21, v24
    v_sub_f32 v22, v22, v24
    v_sub_f32 v23, v23, v24
    v_mul_f32 v16, 0x3fb8aa3b, v16
    v_mul_f32 v17, 0x3fb8aa3b, v17
    v_mul_f32 v18, 0x3fb8aa3b, v18
    v_mul_f32 v19, 0x3fb8aa3b, v19
    v_mul_f32 v20, 0x3fb8aa3b, v20
    v_mul_f32 v21, 0x3fb8aa3b, v21
    v_mul_f32 v22, 0x3fb8aa3b, v22
    v_mul_f32 v23, 0x3fb8aa3b, v23
    v_exp_f32 v16, v16
    v_exp_f32 v17, v17
    v_exp_f32 v18, v18
    v_exp_f32 v19, v19
    v_exp_f32 v20, v20
    v_exp_f32 v21, v21
    v_exp_f32 v22, v22
    v_exp_f32 v23, v23
    v_mul_u32_u24 v29, 1088, v6
    v_lshl_add_u32 v29, v5, 2, v29
    v_lshl_add_u32 v29, v7, 1, v29
    s_lshl_b32 s9, s12, 7
    s_add_u32 s9, s9, 155648
    v_add_u32 v29, s9, v29
    v_cvt_pk_bf16_f32 v32, v16, v16
    ds_write_b16 v29, v32 offset:0
    v_cvt_pk_bf16_f32 v33, v17, v17
    ds_write_b16 v29, v33 offset:16
    v_cvt_pk_bf16_f32 v34, v18, v18
    ds_write_b16 v29, v34 offset:32
    v_cvt_pk_bf16_f32 v35, v19, v19
    ds_write_b16 v29, v35 offset:48
    v_cvt_pk_bf16_f32 v36, v20, v20
    ds_write_b16 v29, v36 offset:64
    v_cvt_pk_bf16_f32 v37, v21, v21
    ds_write_b16 v29, v37 offset:80
    v_cvt_pk_bf16_f32 v38, v22, v22
    ds_write_b16 v29, v38 offset:96
    v_cvt_pk_bf16_f32 v39, v23, v23
    ds_write_b16 v29, v39 offset:112
    v_add_f32 v24, v16, v17
    v_add_f32 v25, v18, v19
    v_add_f32 v30, v20, v21
    v_add_f32 v31, v22, v23
    v_add_f32 v24, v24, v25
    v_add_f32 v30, v30, v31
    v_add_f32 v24, v24, v30
    s_nop 1
    v_add_f32_dpp v24, v24, v24 quad_perm:[1,0,3,2] row_mask:0xf bank_mask:0xf
    v_mov_b32 v25, v24
    s_nop 1
    v_permlane16_swap_b32 v24, v25
    v_add_f32 v24, v24, v25
    v_mov_b32 v25, v24
    s_nop 1
    v_permlane32_swap_b32 v24, v25
    v_add_f32 v24, v24, v25
    v_add_u32 v27, 128, v27
    ds_write_b32 v27, v24
    s_mov_b64 exec, 1
    ds_add_u32 v2, v1 offset:24
    s_mov_b64 exec, -1
    s_mov_b32 s60, 0
    s_mov_b64 exec, 1
Lw_8:
    ds_read_b32 v25, v2 offset:24
    s_waitcnt lgkmcnt(0)
    v_readfirstlane_b32 s62, v25
    s_cmp_ge_u32 s62, 8
    s_cbranch_scc1 Ld_9
    s_add_u32 s60, s60, 1
    s_cmp_lt_u32 s60, 4194304
    s_nop 0
    s_cbranch_scc1 Lw_8
    s_mov_b32 s61, 259
    s_branch L_fail
Ld_9:
    s_mov_b64 exec, -1
    v_and_b32 v6, 3, v4
    v_mul_u32_u24 v29, 1088, v6
    v_lshl_add_u32 v29, v5, 4, v29
    v_add_u32 v29, 155648, v29
    ds_read_b128 v[64:67], v29 offset:0
    ds_read_b128 v[68:71], v29 offset:64
    ds_read_b128 v[72:75], v29 offset:128
    ds_read_b128 v[76:79], v29 offset:192
    ds_read_b128 v[80:83], v29 offset:256
    ds_read_b128 v[84:87], v29 offset:320
    ds_read_b128 v[88:91], v29 offset:384
    ds_read_b128 v[92:95], v29 offset:448
    ds_read_b128 v[96:99], v29 offset:512
    ds_read_b128 v[100:103], v29 offset:576
    ds_read_b128 v[104:107], v29 offset:640
    ds_read_b128 v[108:111], v29 offset:704
    ds_read_b128 v[112:115], v29 offset:768
    ds_read_b128 v[116:119], v29 offset:832
    ds_read_b128 v[120:123], v29 offset:896
    ds_read_b128 v[124:127], v29 offset:960
    v_lshrrev_b32 v8, 2, v4
    v_and_b32 v9, 3, v4
    v_and_b32 v10, 1, v5
    v_lshl_add_u32 v10, v10, 2, v8
    v_xor_b32 v10, s12, v10
    v_lshl_add_u32 v11, v5, 3, v8
    v_lshlrev_b32 v11, 8, v11
    v_lshl_add_u32 v11, v10, 5, v11
    v_lshl_add_u32 v11, v9, 3, v11
    v_add_u32 v12, 0x10000, v11
    v_lshlrev_b32 v13, 14, v6
    v_lshl_add_u32 v13, v5, 4, v13
    s_lshl_b32 s9, s4, 16
    s_lshl_b32 s10, s5, 9
    s_add_u32 s9, s9, s10
    s_lshl_b32 s10, s12, 6
    s_add_u32 s9, s9, s10
    s_add_u32 s14, s9, 720896
    s_mov_b32 s63, 0
    s_waitcnt lgkmcnt(0)
    s_cmp_ge_u32 s63, 1
    s_cbranch_scc1 Lok_10
    s_mov_b32 s60, 0
    s_mov_b64 exec, 1
Lp_11:
    ds_read_b128 v[24:27], v2 offset:32
    s_waitcnt lgkmcnt(0)
    v_min_u32 v24, v24, v25
    v_min3_u32 v24, v24, v26, v27
    s_nop 0
    v_readfirstlane_b32 s62, v24
    s_cmp_ge_u32 s62, 1
    s_cbranch_scc1 Ld_12
    s_sleep 4
    s_add_u32 s60, s60, 1
    s_cmp_lt_u32 s60, 4194304
    s_cbranch_scc1 Lp_11
    s_mov_b32 s61, 261
    s_branch L_fail
Ld_12:
    s_mov_b64 exec, -1
    s_mov_b32 s63, s62
Lok_10:
    ds_read_b64_tr_b16 v[32:33], v11 offset:0
    ds_read_b64_tr_b16 v[34:35], v11 offset:1024
    s_cmp_ge_u32 s63, 2
    s_cbranch_scc1 Lok_13
    s_mov_b32 s60, 0
    s_mov_b64 exec, 1
Lp_14:
    ds_read_b128 v[24:27], v2 offset:32
    s_waitcnt lgkmcnt(0)
    v_min_u32 v24, v24, v25
    v_min3_u32 v24, v24, v26, v27
    s_nop 0
    v_readfirstlane_b32 s62, v24
    s_cmp_ge_u32 s62, 2
    s_cbranch_scc1 Ld_15
    s_sleep 4
    s_add_u32 s60, s60, 1
    s_cmp_lt_u32 s60, 4194304
    s_cbranch_scc1 Lp_14
    s_mov_b32 s61, 261
    s_branch L_fail
Ld_15:
    s_mov_b64 exec, -1
    s_mov_b32 s63, s62
Lok_13:
    ds_read_b64_tr_b16 v[36:37], v11 offset:8192
    ds_read_b64_tr_b16 v[38:39], v11 offset:9216
    s_waitcnt lgkmcnt(2)
    v_mfma_f32_16x16x32_bf16 v[48:51], v[32:35], v[64:67], 0
    s_cmp_ge_u32 s63, 3
    s_cbranch_scc1 Lok_16
    s_mov_b32 s60, 0
    s_mov_b64 exec, 1
    s_nop 3
Lp_17:
    ds_read_b128 v[24:27], v2 offset:32
    s_waitcnt lgkmcnt(0)
    v_min_u32 v24, v24, v25
    v_min3_u32 v24, v24, v26, v27
    s_nop 0
    v_readfirstlane_b32 s62, v24
    s_cmp_ge_u32 s62, 3
    s_cbranch_scc1 Ld_18
    s_sleep 4
    s_add_u32 s60, s60, 1
    s_cmp_lt_u32 s60, 4194304
    s_cbranch_scc1 Lp_17
    s_mov_b32 s61, 261
    s_branch L_fail
Ld_18:
    s_mov_b64 exec, -1
    s_mov_b32 s63, s62
Lok_16:
    ds_read_b64_tr_b16 v[40:41], v11 offset:16384
    ds_read_b64_tr_b16 v[42:43], v11 offset:17408
    s_waitcnt lgkmcnt(2)
    v_mfma_f32_16x16x32_bf16 v[48:51], v[36:39], v[68:71], v[48:51]
    s_cmp_ge_u32 s63, 4
    s_cbranch_scc1 Lok_19
    s_mov_b32 s60, 0
    s_mov_b64 exec, 1
    s_nop 3
Lp_20:
    ds_read_b128 v[24:27], v2 offset:32
    s_waitcnt lgkmcnt(0)
    v_min_u32 v24, v24, v25
    v_min3_u32 v24, v24, v26, v27
    s_nop 0
    v_readfirstlane_b32 s62, v24
    s_cmp_ge_u32 s62, 4
    s_cbranch_scc1 Ld_21
    s_sleep 4
    s_add_u32 s60, s60, 1
    s_cmp_lt_u32 s60, 4194304
    s_cbranch_scc1 Lp_20
    s_mov_b32 s61, 261
    s_branch L_fail
Ld_21:
    s_mov_b64 exec, -1
    s_mov_b32 s63, s62
Lok_19:
    ds_read_b64_tr_b16 v[44:45], v11 offset:24576
    ds_read_b64_tr_b16 v[46:47], v11 offset:25600
    s_waitcnt lgkmcnt(2)
    v_mfma_f32_16x16x32_bf16 v[48:51], v[40:43], v[72:75], v[48:51]
    s_cmp_ge_u32 s63, 5
    s_cbranch_scc1 Lok_22
    s_mov_b32 s60, 0
    s_mov_b64 exec, 1
    s_nop 3
Lp_23:
    ds_read_b128 v[24:27], v2 offset:32
    s_waitcnt lgkmcnt(0)
    v_min_u32 v24, v24, v25
    v_min3_u32 v24, v24, v26, v27
    s_nop 0
    v_readfirstlane_b32 s62, v24
    s_cmp_ge_u32 s62, 5
    s_cbranch_scc1 Ld_24
    s_sleep 4
    s_add_u32 s60, s60, 1
    s_cmp_lt_u32 s60, 4194304
    s_cbranch_scc1 Lp_23
    s_mov_b32 s61, 261
    s_branch L_fail
Ld_24:
    s_mov_b64 exec, -1
    s_mov_b32 s63, s62
Lok_22:
    ds_read_b64_tr_b16 v[32:33], v11 offset:32768
    ds_read_b64_tr_b16 v[34:35], v11 offset:33792
    s_waitcnt lgkmcnt(2)
    v_mfma_f32_16x16x32_bf16 v[48:51], v[44:47], v[76:79], v[48:51]
    s_cmp_ge_u32 s63, 6
    s_cbranch_scc1 Lok_25
    s_mov_b32 s60, 0
    s_mov_b64 exec, 1
    s_nop 3
Lp_26:
    ds_read_b128 v[24:27], v2 offset:32
    s_waitcnt lgkmcnt(0)
    v_min_u32 v24, v24, v25
    v_min3_u32 v24, v24, v26, v27
    s_nop 0
    v_readfirstlane_b32 s62, v24
    s_cmp_ge_u32 s62, 6
    s_cbranch_scc1 Ld_27
    s_sleep 4
    s_add_u32 s60, s60, 1
    s_cmp_lt_u32 s60, 4194304
    s_cbranch_scc1 Lp_26
    s_mov_b32 s61, 261
    s_branch L_fail
Ld_27:
    s_mov_b64 exec, -1
    s_mov_b32 s63, s62
Lok_25:
    ds_read_b64_tr_b16 v[36:37], v11 offset:40960
    ds_read_b64_tr_b16 v[38:39], v11 offset:41984
    s_waitcnt lgkmcnt(2)
    v_mfma_f32_16x16x32_bf16 v[48:51], v[32:35], v[80:83], v[48:51]
    s_cmp_ge_u32 s63, 7
    s_cbranch_scc1 Lok_28
    s_mov_b32 s60, 0
    s_mov_b64 exec, 1
    s_nop 3
Lp_29:
    ds_read_b128 v[24:27], v2 offset:32
    s_waitcnt lgkmcnt(0)
    v_min_u32 v24, v24, v25
    v_min3_u32 v24, v24, v26, v27
    s_nop 0
    v_readfirstlane_b32 s62, v24
    s_cmp_ge_u32 s62, 7
    s_cbranch_scc1 Ld_30
    s_sleep 4
    s_add_u32 s60, s60, 1
    s_cmp_lt_u32 s60, 4194304
    s_cbranch_scc1 Lp_29
    s_mov_b32 s61, 261
    s_branch L_fail
Ld_30:
    s_mov_b64 exec, -1
    s_mov_b32 s63, s62
Lok_28:
    ds_read_b64_tr_b16 v[40:41], v11 offset:49152
    ds_read_b64_tr_b16 v[42:43], v11 offset:50176
    s_waitcnt lgkmcnt(2)
    v_mfma_f32_16x16x32_bf16 v[48:51], v[36:39], v[84:87], v[48:51]
    s_cmp_ge_u32 s63, 8
    s_cbranch_scc1 Lok_31
    s_mov_b32 s60, 0
    s_mov_b64 exec, 1
    s_nop 3
Lp_32:
    ds_read_b128 v[24:27], v2 offset:32
    s_waitcnt lgkmcnt(0)
    v_min_u32 v24, v24, v25
    v_min3_u32 v24, v24, v26, v27
    s_nop 0
    v_readfirstlane_b32 s62, v24
    s_cmp_ge_u32 s62, 8
    s_cbranch_scc1 Ld_33
    s_sleep 4
    s_add_u32 s60, s60, 1
    s_cmp_lt_u32 s60, 4194304
    s_cbranch_scc1 Lp_32
    s_mov_b32 s61, 261
    s_branch L_fail
Ld_33:
    s_mov_b64 exec, -1
    s_mov_b32 s63, s62
Lok_31:
    ds_read_b64_tr_b16 v[44:45], v11 offset:57344
    ds_read_b64_tr_b16 v[46:47], v11 offset:58368
    s_waitcnt lgkmcnt(2)
    v_mfma_f32_16x16x32_bf16 v[48:51], v[40:43], v[88:91], v[48:51]
    s_cmp_ge_u32 s63, 9
    s_cbranch_scc1 Lok_34
    s_mov_b32 s60, 0
    s_mov_b64 exec, 1
    s_nop 3
Lp_35:
    ds_read_b128 v[24:27], v2 offset:32
    s_waitcnt lgkmcnt(0)
    v_min_u32 v24, v24, v25
    v_min3_u32 v24, v24, v26, v27
    s_nop 0
    v_readfirstlane_b32 s62, v24
    s_cmp_ge_u32 s62, 9
    s_cbranch_scc1 Ld_36
    s_sleep 4
    s_add_u32 s60, s60, 1
    s_cmp_lt_u32 s60, 4194304
    s_cbranch_scc1 Lp_35
    s_mov_b32 s61, 261
    s_branch L_fail
Ld_36:
    s_mov_b64 exec, -1
    s_mov_b32 s63, s62
Lok_34:
    ds_read_b64_tr_b16 v[32:33], v12 offset:0
    ds_read_b64_tr_b16 v[34:35], v12 offset:1024
    s_waitcnt lgkmcnt(2)
    v_mfma_f32_16x16x32_bf16 v[48:51], v[44:47], v[92:95], v[48:51]
    s_cmp_ge_u32 s63, 10
    s_cbranch_scc1 Lok_37
    s_mov_b32 s60, 0
    s_mov_b64 exec, 1
    s_nop 3
Lp_38:
    ds_read_b128 v[24:27], v2 offset:32
    s_waitcnt lgkmcnt(0)
    v_min_u32 v24, v24, v25
    v_min3_u32 v24, v24, v26, v27
    s_nop 0
    v_readfirstlane_b32 s62, v24
    s_cmp_ge_u32 s62, 10
    s_cbranch_scc1 Ld_39
    s_sleep 4
    s_add_u32 s60, s60, 1
    s_cmp_lt_u32 s60, 4194304
    s_cbranch_scc1 Lp_38
    s_mov_b32 s61, 261
    s_branch L_fail
Ld_39:
    s_mov_b64 exec, -1
    s_mov_b32 s63, s62
Lok_37:
    ds_read_b64_tr_b16 v[36:37], v12 offset:8192
    ds_read_b64_tr_b16 v[38:39], v12 offset:9216
    s_waitcnt lgkmcnt(2)
    v_mfma_f32_16x16x32_bf16 v[48:51], v[32:35], v[96:99], v[48:51]
    s_cmp_ge_u32 s63, 11
    s_cbranch_scc1 Lok_40
    s_mov_b32 s60, 0
    s_mov_b64 exec, 1
    s_nop 3
Lp_41:
    ds_read_b128 v[24:27], v2 offset:32
    s_waitcnt lgkmcnt(0)
    v_min_u32 v24, v24, v25
    v_min3_u32 v24, v24, v26, v27
    s_nop 0
    v_readfirstlane_b32 s62, v24
    s_cmp_ge_u32 s62, 11
    s_cbranch_scc1 Ld_42
    s_sleep 4
    s_add_u32 s60, s60, 1
    s_cmp_lt_u32 s60, 4194304
    s_cbranch_scc1 Lp_41
    s_mov_b32 s61, 261
    s_branch L_fail
Ld_42:
    s_mov_b64 exec, -1
    s_mov_b32 s63, s62
Lok_40:
    ds_read_b64_tr_b16 v[40:41], v12 offset:16384
    ds_read_b64_tr_b16 v[42:43], v12 offset:17408
    s_waitcnt lgkmcnt(2)
    v_mfma_f32_16x16x32_bf16 v[48:51], v[36:39], v[100:103], v[48:51]
    s_cmp_ge_u32 s63, 12
    s_cbranch_scc1 Lok_43
    s_mov_b32 s60, 0
    s_mov_b64 exec, 1
    s_nop 3
Lp_44:
    ds_read_b128 v[24:27], v2 offset:32
    s_waitcnt lgkmcnt(0)
    v_min_u32 v24, v24, v25
    v_min3_u32 v24, v24, v26, v27
    s_nop 0
    v_readfirstlane_b32 s62, v24
    s_cmp_ge_u32 s62, 12
    s_cbranch_scc1 Ld_45
    s_sleep 4
    s_add_u32 s60, s60, 1
    s_cmp_lt_u32 s60, 4194304
    s_cbranch_scc1 Lp_44
    s_mov_b32 s61, 261
    s_branch L_fail
Ld_45:
    s_mov_b64 exec, -1
    s_mov_b32 s63, s62
Lok_43:
    ds_read_b64_tr_b16 v[44:45], v12 offset:24576
    ds_read_b64_tr_b16 v[46:47], v12 offset:25600
    s_waitcnt lgkmcnt(2)
    v_mfma_f32_16x16x32_bf16 v[48:51], v[40:43], v[104:107], v[48:51]
    ds_read_b32 v14, v2 offset:56
    s_mov_b32 s60, 0
    s_mov_b64 exec, 1
    s_nop 4
Lw_47:
    ds_read_b32 v24, v2 offset:52
    s_waitcnt lgkmcnt(0)
    v_readfirstlane_b32 s62, v24
    s_cmp_ge_u32 s62, 1
    s_cbranch_scc1 Ld_48
    s_sleep 1
    s_add_u32 s60, s60, 1
    s_cmp_lt_u32 s60, 4194304
    s_cbranch_scc1 Lw_47
    s_mov_b32 s61, 262
    s_branch L_fail
Ld_48:
    s_mov_b64 exec, -1
    s_mov_b32 s15, s62
    s_cmp_ge_u32 s63, 13
    s_cbranch_scc1 Lok_46
    s_mov_b32 s60, 0
    s_mov_b64 exec, 1
Lp_49:
    ds_read_b128 v[24:27], v2 offset:32
    s_waitcnt lgkmcnt(0)
    v_min_u32 v24, v24, v25
    v_min3_u32 v24, v24, v26, v27
    s_nop 0
    v_readfirstlane_b32 s62, v24
    s_cmp_ge_u32 s62, 13
    s_cbranch_scc1 Ld_50
    s_add_u32 s60, s60, 1
    s_cmp_lt_u32 s60, 4194304
    s_nop 0
    s_cbranch_scc1 Lp_49
    s_mov_b32 s61, 261
    s_branch L_fail
Ld_50:
    s_mov_b64 exec, -1
    s_mov_b32 s63, s62
Lok_46:
    ds_read_b64_tr_b16 v[32:33], v12 offset:32768
    ds_read_b64_tr_b16 v[34:35], v12 offset:33792
    s_waitcnt lgkmcnt(2)
    v_mfma_f32_16x16x32_bf16 v[48:51], v[44:47], v[108:111], v[48:51]
    s_cmp_ge_u32 s63, 14
    s_cbranch_scc1 Lok_51
    s_mov_b32 s60, 0
    s_mov_b64 exec, 1
    s_nop 3
Lp_52:
    ds_read_b128 v[24:27], v2 offset:32
    s_waitcnt lgkmcnt(0)
    v_min_u32 v24, v24, v25
    v_min3_u32 v24, v24, v26, v27
    s_nop 0
    v_readfirstlane_b32 s62, v24
    s_cmp_ge_u32 s62, 14
    s_cbranch_scc1 Ld_53
    s_add_u32 s60, s60, 1
    s_cmp_lt_u32 s60, 4194304
    s_nop 0
    s_cbranch_scc1 Lp_52
    s_mov_b32 s61, 261
    s_branch L_fail
Ld_53:
    s_mov_b64 exec, -1
    s_mov_b32 s63, s62
Lok_51:
    ds_read_b64_tr_b16 v[36:37], v12 offset:40960
    ds_read_b64_tr_b16 v[38:39], v12 offset:41984
    s_waitcnt lgkmcnt(2)
    v_mfma_f32_16x16x32_bf16 v[48:51], v[32:35], v[112:115], v[48:51]
    s_cmp_ge_u32 s63, 15
    s_cbranch_scc1 Lok_54
    s_mov_b32 s60, 0
    s_mov_b64 exec, 1
    s_nop 3
Lp_55:
    ds_read_b128 v[24:27], v2 offset:32
    s_waitcnt lgkmcnt(0)
    v_min_u32 v24, v24, v25
    v_min3_u32 v24, v24, v26, v27
    s_nop 0
    v_readfirstlane_b32 s62, v24
    s_cmp_ge_u32 s62, 15
    s_cbranch_scc1 Ld_56
    s_add_u32 s60, s60, 1
    s_cmp_lt_u32 s60, 4194304
    s_nop 0
    s_cbranch_scc1 Lp_55
    s_mov_b32 s61, 261
    s_branch L_fail
Ld_56:
    s_mov_b64 exec, -1
    s_mov_b32 s63, s62
Lok_54:
    ds_read_b64_tr_b16 v[40:41], v12 offset:49152
    ds_read_b64_tr_b16 v[42:43], v12 offset:50176
    s_waitcnt lgkmcnt(2)
    v_mfma_f32_16x16x32_bf16 v[48:51], v[36:39], v[116:119], v[48:51]
    s_cmp_ge_u32 s63, 16
    s_cbranch_scc1 Lok_57
    s_mov_b32 s60, 0
    s_mov_b64 exec, 1
    s_nop 3
Lp_58:
    ds_read_b128 v[24:27], v2 offset:32
    s_waitcnt lgkmcnt(0)
    v_min_u32 v24, v24, v25
    v_min3_u32 v24, v24, v26, v27
    s_nop 0
    v_readfirstlane_b32 s62, v24
    s_cmp_ge_u32 s62, 16
    s_cbranch_scc1 Ld_59
    s_add_u32 s60, s60, 1
    s_cmp_lt_u32 s60, 4194304
    s_nop 0
    s_cbranch_scc1 Lp_58
    s_mov_b32 s61, 261
    s_branch L_fail
Ld_59:
    s_mov_b64 exec, -1
    s_mov_b32 s63, s62
Lok_57:
    ds_read_b64_tr_b16 v[44:45], v12 offset:57344
    ds_read_b64_tr_b16 v[46:47], v12 offset:58368
    s_waitcnt lgkmcnt(2)
    v_mfma_f32_16x16x32_bf16 v[48:51], v[40:43], v[120:123], v[48:51]
    s_mov_b32 s10, 0x000f000f
    s_waitcnt lgkmcnt(0)
    v_mfma_f32_16x16x32_bf16 v[48:51], v[44:47], v[124:127], v[48:51]
    s_nop 7
    v_and_or_b32 v48, v48, s58, v14
    v_and_or_b32 v49, v49, s58, v14
    v_and_or_b32 v50, v50, s58, v14
    v_and_or_b32 v51, v51, s58, v14
    s_mov_b32 exec_lo, s10
    s_mov_b32 exec_hi, s10
    s_cmp_eq_u32 s15, 1
    s_cbranch_scc0 Lr_60
    buffer_store_dwordx4 v[48:51], v13, s[52:55], s14 offen
    s_branch Lj_61
Lr_60:
    buffer_store_dwordx4 v[48:51], v13, s[52:55], s14 offen sc1
Lj_61:
    s_mov_b64 exec, 1
    ds_add_u32 v2, v1 offset:48
    s_mov_b64 exec, -1
    s_endpgm
L_loader:
    s_barrier
    s_waitcnt lgkmcnt(0)
    s_mov_b32 s52, s36
    s_mov_b32 s53, s37
    s_mov_b32 s54, 3145728
    s_mov_b32 s55, 0x20000
    s_sub_u32 s12, s3, 12
    s_lshl_b32 s9, s6, 3
    s_add_u32 s9, s9, s4
    s_lshl_b32 s9, s9, 22
    s_lshl_b32 s10, s7, 17
    s_add_u32 s9, s9, s10
    s_add_u32 s9, s9, 3145728
    s_add_u32 s40, s20, s9
    s_addc_u32 s41, s21, 0
    s_mov_b32 s42, 131072
    s_mov_b32 s43, 0x20000
    s_mov_b32 s44, s24
    s_mov_b32 s45, s25
    s_mov_b32 s46, 4194304
    s_mov_b32 s47, 0x20000
    v_lshrrev_b32 v5, 4, v0
    s_and_b32 s9, s12, 1
    s_lshl_b32 s9, s9, 2
    v_or_b32 v6, s9, v5
    v_lshlrev_b32 v6, 1, v6
    v_and_b32 v7, 15, v0
    v_xor_b32 v6, v6, v7
    v_lshlrev_b32 v6, 4, v6
    v_lshl_add_u32 v8, v5, 8, v6
    s_lshl_b32 s9, s12, 2
    s_add_u32 s9, s9, 32
    v_add_u32 v10, s9, v2
    v_lshrrev_b32 v12, 3, v0
    v_and_b32 v13, 7, v0
    v_lshlrev_b32 v13, 4, v13
    v_lshl_add_u32 v12, v12, 10, v13
    s_lshl_b32 s9, s4, 2
    s_add_u32 s9, s9, s6
    s_lshl_b32 s9, s9, 7
    s_lshl_b32 s10, s12, 5
    s_add_u32 s9, s9, s10
    s_lshl_b32 s9, s9, 10
    s_lshl_b32 s10, s7, 7
    s_add_u32 s15, s9, s10
    s_lshl_b32 s11, s12, 11
    s_add_u32 s14, s8, s12
    s_mov_b32 s60, 0
    s_mov_b64 exec, 1
Lw_62:
    ds_read_b32 v24, v2 offset:8
    s_waitcnt lgkmcnt(0)
    v_readfirstlane_b32 s62, v24
    s_cmp_ge_u32 s62, 6
    s_cbranch_scc1 Ld_63
    s_sleep 4
    s_add_u32 s60, s60, 1
    s_cmp_lt_u32 s60, 4194304
    s_cbranch_scc1 Lw_62
    s_mov_b32 s61, 518
    s_branch L_fail
Ld_63:
    s_mov_b64 exec, -1
    s_mov_b32 s60, 0
    s_mov_b64 exec, 1
Lw_64:
    ds_read_b32 v24, v2 offset:8
    s_waitcnt lgkmcnt(0)
    v_readfirstlane_b32 s62, v24
    s_cmp_ge_u32 s62, 8
    s_cbranch_scc1 Ld_65
    s_sleep 1
    s_add_u32 s60, s60, 1
    s_cmp_lt_u32 s60, 4194304
    s_cbranch_scc1 Lw_64
    s_mov_b32 s61, 513
    s_branch L_fail
Ld_65:
    s_mov_b64 exec, -1
    s_mov_b32 s60, 0
    s_mov_b64 exec, 1
Lw_66:
    ds_read_b32 v24, v2 offset:4
    s_waitcnt lgkmcnt(0)
    v_readfirstlane_b32 s62, v24
    s_cmp_ge_u32 s62, 4
    s_cbranch_scc1 Ld_67
    s_sleep 1
    s_add_u32 s60, s60, 1
    s_cmp_lt_u32 s60, 4194304
    s_cbranch_scc1 Lw_66
    s_mov_b32 s61, 514
    s_branch L_fail
Ld_67:
    s_mov_b64 exec, -1
    s_add_u32 s10, s14, 0
    s_and_b32 s10, s10, 63
    s_lshl_b32 s10, s10, 11
    s_add_u32 s13, s11, 0
    s_mov_b32 m0, s13
    s_nop 0
    buffer_load_dwordx4 v8, s[40:43], s10 offen nt lds
    buffer_load_dwordx4 v8, s[40:43], s10 offen offset:1024 nt lds
    s_add_u32 s10, s14, 4
    s_and_b32 s10, s10, 63
    s_lshl_b32 s10, s10, 11
    s_add_u32 s13, s11, 8192
    s_mov_b32 m0, s13
    s_nop 0
    buffer_load_dwordx4 v8, s[40:43], s10 offen nt lds
    buffer_load_dwordx4 v8, s[40:43], s10 offen offset:1024 nt lds
    s_add_u32 s10, s14, 8
    s_and_b32 s10, s10, 63
    s_lshl_b32 s10, s10, 11
    s_add_u32 s13, s11, 16384
    s_mov_b32 m0, s13
    s_nop 0
    buffer_load_dwordx4 v8, s[40:43], s10 offen nt lds
    buffer_load_dwordx4 v8, s[40:43], s10 offen offset:1024 nt lds
    s_add_u32 s10, s14, 12
    s_and_b32 s10, s10, 63
    s_lshl_b32 s10, s10, 11
    s_add_u32 s13, s11, 24576
    s_mov_b32 m0, s13
    s_nop 0
    buffer_load_dwordx4 v8, s[40:43], s10 offen nt lds
    buffer_load_dwordx4 v8, s[40:43], s10 offen offset:1024 nt lds
    s_waitcnt vmcnt(6)
    v_mov_b32 v11, 1
    s_mov_b64 exec, 1
    ds_write_b32 v10, v11
    s_mov_b64 exec, -1
    s_add_u32 s10, s14, 16
    s_and_b32 s10, s10, 63
    s_lshl_b32 s10, s10, 11
    s_add_u32 s13, s11, 32768
    s_mov_b32 m0, s13
    s_nop 0
    buffer_load_dwordx4 v8, s[40:43], s10 offen nt lds
    buffer_load_dwordx4 v8, s[40:43], s10 offen offset:1024 nt lds
    s_waitcnt vmcnt(6)
    v_mov_b32 v11, 2
    s_mov_b64 exec, 1
    ds_write_b32 v10, v11
    s_mov_b64 exec, -1
    s_add_u32 s10, s14, 20
    s_and_b32 s10, s10, 63
    s_lshl_b32 s10, s10, 11
    s_add_u32 s13, s11, 40960
    s_mov_b32 m0, s13
    s_nop 0
    buffer_load_dwordx4 v8, s[40:43], s10 offen nt lds
    buffer_load_dwordx4 v8, s[40:43], s10 offen offset:1024 nt lds
    s_waitcnt vmcnt(6)
    v_mov_b32 v11, 3
    s_mov_b64 exec, 1
    ds_write_b32 v10, v11
    s_mov_b64 exec, -1
    s_add_u32 s10, s14, 24
    s_and_b32 s10, s10, 63
    s_lshl_b32 s10, s10, 11
    s_add_u32 s13, s11, 49152
    s_mov_b32 m0, s13
    s_nop 0
    buffer_load_dwordx4 v8, s[40:43], s10 offen nt lds
    buffer_load_dwordx4 v8, s[40:43], s10 offen offset:1024 nt lds
    s_waitcnt vmcnt(6)
    v_mov_b32 v11, 4
    s_mov_b64 exec, 1
    ds_write_b32 v10, v11
    s_mov_b64 exec, -1
    s_add_u32 s10, s14, 28
    s_and_b32 s10, s10, 63
    s_lshl_b32 s10, s10, 11
    s_add_u32 s13, s11, 57344
    s_mov_b32 m0, s13
    s_nop 0
    buffer_load_dwordx4 v8, s[40:43], s10 offen nt lds
    buffer_load_dwordx4 v8, s[40:43], s10 offen offset:1024 nt lds
    s_waitcnt vmcnt(6)
    v_mov_b32 v11, 5
    s_mov_b64 exec, 1
    ds_write_b32 v10, v11
    s_mov_b64 exec, -1
    s_add_u32 s10, s14, 32
    s_and_b32 s10, s10, 63
    s_lshl_b32 s10, s10, 11
    s_add_u32 s13, s11, 65536
    s_mov_b32 m0, s13
    s_nop 0
    buffer_load_dwordx4 v8, s[40:43], s10 offen nt lds
    buffer_load_dwordx4 v8, s[40:43], s10 offen offset:1024 nt lds
    s_waitcnt vmcnt(6)
    v_mov_b32 v11, 6
    s_mov_b64 exec, 1
    ds_write_b32 v10, v11
    s_mov_b64 exec, -1
    s_add_u32 s10, s14, 36
    s_and_b32 s10, s10, 63
    s_lshl_b32 s10, s10, 11
    s_add_u32 s13, s11, 73728
    s_mov_b32 m0, s13
    s_nop 0
    buffer_load_dwordx4 v8, s[40:43], s10 offen nt lds
    buffer_load_dwordx4 v8, s[40:43], s10 offen offset:1024 nt lds
    s_waitcnt vmcnt(6)
    v_mov_b32 v11, 7
    s_mov_b64 exec, 1
    ds_write_b32 v10, v11
    s_mov_b64 exec, -1
    s_add_u32 s10, s14, 40
    s_and_b32 s10, s10, 63
    s_lshl_b32 s10, s10, 11
    s_add_u32 s13, s11, 81920
    s_mov_b32 m0, s13
    s_nop 0
    buffer_load_dwordx4 v8, s[40:43], s10 offen nt lds
    buffer_load_dwordx4 v8, s[40:43], s10 offen offset:1024 nt lds
    s_waitcnt vmcnt(6)
    v_mov_b32 v11, 8
    s_mov_b64 exec, 1
    ds_write_b32 v10, v11
    s_mov_b64 exec, -1
    s_add_u32 s10, s14, 44
    s_and_b32 s10, s10, 63
    s_lshl_b32 s10, s10, 11
    s_add_u32 s13, s11, 90112
    s_mov_b32 m0, s13
    s_nop 0
    buffer_load_dwordx4 v8, s[40:43], s10 offen nt lds
    buffer_load_dwordx4 v8, s[40:43], s10 offen offset:1024 nt lds
    s_waitcnt vmcnt(6)
    v_mov_b32 v11, 9
    s_mov_b64 exec, 1
    ds_write_b32 v10, v11
    s_mov_b64 exec, -1
    s_add_u32 s10, s14, 48
    s_and_b32 s10, s10, 63
    s_lshl_b32 s10, s10, 11
    s_add_u32 s13, s11, 98304
    s_mov_b32 m0, s13
    s_nop 0
    buffer_load_dwordx4 v8, s[40:43], s10 offen nt lds
    buffer_load_dwordx4 v8, s[40:43], s10 offen offset:1024 nt lds
    s_waitcnt vmcnt(6)
    v_mov_b32 v11, 10
    s_mov_b64 exec, 1
    ds_write_b32 v10, v11
    s_mov_b64 exec, -1
    s_add_u32 s10, s14, 52
    s_and_b32 s10, s10, 63
    s_lshl_b32 s10, s10, 11
    s_add_u32 s13, s11, 106496
    s_mov_b32 m0, s13
    s_nop 0
    buffer_load_dwordx4 v8, s[40:43], s10 offen nt lds
    buffer_load_dwordx4 v8, s[40:43], s10 offen offset:1024 nt lds
    s_waitcnt vmcnt(6)
    v_mov_b32 v11, 11
    s_mov_b64 exec, 1
    ds_write_b32 v10, v11
    s_mov_b64 exec, -1
    s_add_u32 s10, s14, 56
    s_and_b32 s10, s10, 63
    s_lshl_b32 s10, s10, 11
    s_add_u32 s13, s11, 114688
    s_mov_b32 m0, s13
    s_nop 0
    buffer_load_dwordx4 v8, s[40:43], s10 offen nt lds
    buffer_load_dwordx4 v8, s[40:43], s10 offen offset:1024 nt lds
    s_waitcnt vmcnt(6)
    v_mov_b32 v11, 12
    s_mov_b64 exec, 1
    ds_write_b32 v10, v11
    s_mov_b64 exec, -1
    s_add_u32 s10, s14, 60
    s_and_b32 s10, s10, 63
    s_lshl_b32 s10, s10, 11
    s_add_u32 s13, s11, 122880
    s_mov_b32 m0, s13
    s_nop 0
    buffer_load_dwordx4 v8, s[40:43], s10 offen nt lds
    buffer_load_dwordx4 v8, s[40:43], s10 offen offset:1024 nt lds
    s_mov_b32 s60, 0
    s_mov_b64 exec, 1
Lw_68:
    ds_read_b32 v24, v2 offset:84
    s_waitcnt lgkmcnt(0)
    v_readfirstlane_b32 s62, v24
    s_cmp_ge_u32 s62, 1
    s_cbranch_scc1 Ld_69
    s_add_u32 s60, s60, 1
    s_cmp_lt_u32 s60, 4194304
    s_nop 0
    s_cbranch_scc1 Lw_68
    s_mov_b32 s61, 519
    s_branch L_fail
Ld_69:
    s_mov_b64 exec, -1
    s_lshl_b32 s11, s12, 12
    s_add_u32 s13, s11, 131072
    s_mov_b32 m0, s13
    s_add_u32 s10, s15, 0
    buffer_load_dwordx4 v12, s[44:47], s10 offen nt lds
    s_add_u32 s13, s11, 132096
    s_mov_b32 m0, s13
    s_add_u32 s10, s15, 8192
    buffer_load_dwordx4 v12, s[44:47], s10 offen nt lds
    s_add_u32 s13, s11, 133120
    s_mov_b32 m0, s13
    s_add_u32 s10, s15, 16384
    buffer_load_dwordx4 v12, s[44:47], s10 offen nt lds
    s_add_u32 s13, s11, 134144
    s_mov_b32 m0, s13
    s_add_u32 s10, s15, 24576
    buffer_load_dwordx4 v12, s[44:47], s10 offen nt lds
    s_waitcnt vmcnt(10)
    v_mov_b32 v11, 13
    s_mov_b64 exec, 1
    ds_write_b32 v10, v11
    s_mov_b64 exec, -1
    s_waitcnt vmcnt(8)
    v_mov_b32 v11, 14
    s_mov_b64 exec, 1
    ds_write_b32 v10, v11
    s_mov_b64 exec, -1
    s_waitcnt vmcnt(6)
    v_mov_b32 v11, 15
    s_mov_b64 exec, 1
    ds_write_b32 v10, v11
    s_mov_b64 exec, -1
    s_waitcnt vmcnt(4)
    v_mov_b32 v11, 16
    s_mov_b64 exec, 1
    ds_write_b32 v10, v11
    s_mov_b64 exec, -1
    s_waitcnt vmcnt(0)
    v_mov_b32 v11, 17
    s_mov_b64 exec, 1
    ds_write_b32 v10, v11
    s_mov_b64 exec, -1
    s_mov_b32 s90, s2
    s_cmp_lt_u32 s2, 64
    s_cbranch_scc0 L_ld10
    s_cmp_eq_u32 s3, 12
    s_cbranch_scc1 Lfin_70
L_ld10:
L_ldend:
    s_waitcnt lgkmcnt(0)
    s_endpgm
Lfin_70:
    s_setprio 3
    ds_read_b32 v14, v2 offset:56
    ds_read_b32 v103, v2 offset:60
    v_mov_b32 v19, 0
    s_mov_b32 s40, s16
    s_mov_b32 s41, s17
    s_mov_b32 s42, 4096
    s_mov_b32 s43, 0x20000
    s_mov_b32 s44, s32
    s_mov_b32 s45, s33
    s_mov_b32 s46, 4096
    s_mov_b32 s47, 0x20000
    v_lshlrev_b32 v18, 4, v0
    v_lshrrev_b32 v20, 1, v5
    v_and_b32 v21, 1, v5
    v_lshl_add_u32 v20, v21, 1, v20
    v_and_b32 v21, 1, v0
    v_lshl_add_u32 v20, v21, 2, v20
    v_lshrrev_b32 v21, 1, v0
    v_and_b32 v21, 3, v21
    v_lshl_add_u32 v20, v21, 9, v20
    s_lshl_b32 s10, s90, 3
    v_add_u32 v20, s10, v20
    v_lshlrev_b32 v100, 1, v20
    buffer_load_ushort v101, v100, s[40:43], 0 offen
    s_lshl_b32 s9, s90, 12
    s_add_u32 s9, s9, 1310720
    v_add_u32 v22, 3072, v18
    v_add_u32 v23, 2048, v18
    s_mov_b32 s56, 0
    s_mov_b32 s57, -1
    v_cndmask_b32 v22, v22, v23, s[56:57]
    s_waitcnt lgkmcnt(0)
    s_mov_b32 s60, 0
Lg_72:
    buffer_load_dwordx4 v[64:67], v18, s[52:55], s9 offen offset:0 sc1
    buffer_load_dwordx4 v[68:71], v18, s[52:55], s9 offen offset:1024 sc1
    buffer_load_dwordx4 v[72:75], v18, s[52:55], s9 offen offset:2048 sc1
    buffer_load_dwordx4 v[76:79], v22, s[52:55], s9 offen sc1
    s_waitcnt vmcnt(0)
    v_xor_b32 v64, v14, v64
    v_xor_b32 v65, v14, v65
    v_xor_b32 v66, v14, v66
    v_xor_b32 v67, v14, v67
    v_xor_b32 v68, v14, v68
    v_xor_b32 v69, v14, v69
    v_xor_b32 v70, v14, v70
    v_xor_b32 v71, v14, v71
    v_xor_b32 v72, v14, v72
    v_xor_b32 v73, v14, v73
    v_xor_b32 v74, v14, v74
    v_xor_b32 v75, v14, v75
    v_xor_b32 v76, v14, v76
    v_xor_b32 v77, v14, v77
    v_xor_b32 v78, v14, v78
    v_xor_b32 v79, v14, v79
    v_or3_b32 v41, v64, v65, v66
    v_or3_b32 v41, v67, v68, v41
    v_or3_b32 v41, v69, v70, v41
    v_or3_b32 v41, v71, v72, v41
    v_or3_b32 v41, v73, v74, v41
    v_or3_b32 v41, v75, v76, v41
    v_or3_b32 v41, v77, v78, v41
    v_or_b32 v41, v79, v41
    v_and_b32 v41, 1023, v41
    v_cmp_ne_u32 vcc, 0, v41
    s_cmp_eq_u64 vcc, 0
    s_cbranch_scc1 Ld_73
    s_mov_b64 exec, vcc
    s_sleep 4
    s_add_u32 s60, s60, 1
    s_cmp_lt_u32 s60, 1048576
    s_cbranch_scc1 Lg_72
    s_mov_b64 exec, -1
    s_mov_b32 s61, 834
    s_branch L_fail
Ld_73:
    s_mov_b64 exec, -1
    v_cndmask_b32 v76, v76, 0, s[56:57]
    v_cndmask_b32 v77, v77, 0, s[56:57]
    v_cndmask_b32 v78, v78, 0, s[56:57]
    v_cndmask_b32 v79, v79, 0, s[56:57]
    v_pk_add_f32 v[64:65], v[64:65], v[68:69]
    v_pk_add_f32 v[72:73], v[72:73], v[76:77]
    v_pk_add_f32 v[66:67], v[66:67], v[70:71]
    v_pk_add_f32 v[74:75], v[74:75], v[78:79]
    v_pk_add_f32 v[64:65], v[64:65], v[72:73]
    v_pk_add_f32 v[66:67], v[66:67], v[74:75]
    s_nop 0
    v_permlane32_swap_b32 v64, v65
    v_permlane32_swap_b32 v66, v67
    v_add_f32 v64, v64, v65
    v_add_f32 v66, v66, v67
    s_nop 1
    v_permlane16_swap_b32 v64, v66
    v_add_f32 v64, v64, v66
    s_nop 1
    v_add_f32_dpp v64, v64, v64 row_ror:8 row_mask:0xf bank_mask:0xf
    v_cvt_pk_bf16_f32 v64, v64, v64
    v_lshlrev_b32 v64, 16, v64
    v_mul_f32 v65, 0xbfb8aa3b, v64
    v_exp_f32 v65, v65
    s_nop 0
    v_add_f32 v65, 1.0, v65
    v_rcp_f32 v65, v65
    s_nop 0
    v_mul_f32 v65, v64, v65
    v_cvt_pk_bf16_f32 v102, v65, v65
    v_lshlrev_b32 v102, 16, v102
    v_lshlrev_b32 v101, 16, v101
    s_lshl_b32 s9, s90, 12
    s_add_u32 s9, s9, 2097152
    s_mov_b32 s60, 0
    s_mov_b64 exec, 1
Lw_74:
    ds_read_b32 v24, v2 offset:76
    s_waitcnt lgkmcnt(0)
    v_readfirstlane_b32 s62, v24
    s_cmp_ge_u32 s62, 1
    s_cbranch_scc1 Ld_75
    s_sleep 1
    s_add_u32 s60, s60, 1
    s_cmp_lt_u32 s60, 4194304
    s_cbranch_scc1 Lw_74
    s_mov_b32 s61, 868
    s_branch L_fail
Ld_75:
    s_mov_b64 exec, -1
    s_mov_b32 s60, 0
Lg_76:
    buffer_load_dwordx4 v[64:67], v18, s[52:55], s9 offen offset:0 sc1
    buffer_load_dwordx4 v[68:71], v18, s[52:55], s9 offen offset:1024 sc1
    buffer_load_dwordx4 v[72:75], v18, s[52:55], s9 offen offset:2048 sc1
    buffer_load_dwordx4 v[76:79], v18, s[52:55], s9 offen offset:3072 sc1
    s_waitcnt vmcnt(0)
    v_xor_b32 v64, v14, v64
    v_xor_b32 v65, v14, v65
    v_xor_b32 v66, v14, v66
    v_xor_b32 v67, v14, v67
    v_xor_b32 v68, v14, v68
    v_xor_b32 v69, v14, v69
    v_xor_b32 v70, v14, v70
    v_xor_b32 v71, v14, v71
    v_xor_b32 v72, v14, v72
    v_xor_b32 v73, v14, v73
    v_xor_b32 v74, v14, v74
    v_xor_b32 v75, v14, v75
    v_xor_b32 v76, v14, v76
    v_xor_b32 v77, v14, v77
    v_xor_b32 v78, v14, v78
    v_xor_b32 v79, v14, v79
    v_or3_b32 v41, v64, v65, v66
    v_or3_b32 v41, v67, v68, v41
    v_or3_b32 v41, v69, v70, v41
    v_or3_b32 v41, v71, v72, v41
    v_or3_b32 v41, v73, v74, v41
    v_or3_b32 v41, v75, v76, v41
    v_or3_b32 v41, v77, v78, v41
    v_or_b32 v41, v79, v41
    v_and_b32 v41, 1023, v41
    v_cmp_ne_u32 vcc, 0, v41
    s_cmp_eq_u64 vcc, 0
    s_cbranch_scc1 Ld_77
    s_mov_b64 exec, vcc
    s_add_u32 s60, s60, 1
    s_cmp_lt_u32 s60, 1048576
    s_cbranch_scc1 Lg_76
    s_mov_b64 exec, -1
    s_mov_b32 s61, 864
    s_branch L_fail
Ld_77:
    s_mov_b64 exec, -1
    s_cmp_eq_u32 s90, 0
    s_cbranch_scc0 Le_78
    s_mov_b64 exec, 1
    buffer_store_dword v103, v19, s[52:55], 0 offen
    s_mov_b64 exec, -1
Le_78:
    v_pk_add_f32 v[64:65], v[64:65], v[68:69]
    v_pk_add_f32 v[72:73], v[72:73], v[76:77]
    v_pk_add_f32 v[66:67], v[66:67], v[70:71]
    v_pk_add_f32 v[74:75], v[74:75], v[78:79]
    v_pk_add_f32 v[64:65], v[64:65], v[72:73]
    v_pk_add_f32 v[66:67], v[66:67], v[74:75]
    s_nop 0
    v_permlane32_swap_b32 v64, v65
    v_permlane32_swap_b32 v66, v67
    v_add_f32 v64, v64, v65
    v_add_f32 v66, v66, v67
    s_nop 1
    v_permlane16_swap_b32 v64, v66
    v_add_f32 v64, v64, v66
    s_nop 1
    v_add_f32_dpp v64, v64, v64 row_ror:8 row_mask:0xf bank_mask:0xf
    v_cvt_pk_bf16_f32 v64, v64, v64
    v_lshlrev_b32 v64, 16, v64
    v_mul_f32 v64, v64, v102
    v_cvt_pk_bf16_f32 v64, v64, v64
    v_lshlrev_b32 v64, 16, v64
    v_add_f32 v64, v101, v64
    v_cvt_pk_bf16_f32 v64, v64, v64
    s_mov_b32 exec_lo, 0x00ff00ff
    s_mov_b32 exec_hi, 0x00ff00ff
    buffer_store_short v64, v100, s[44:47], 0 offen
    s_mov_b64 exec, -1
    s_endpgm
L_aux:
    s_setprio 3
    v_and_b32 v4, 15, v0
    v_lshrrev_b32 v5, 4, v0
    v_lshrrev_b32 v6, 2, v4
    v_and_b32 v7, 3, v4
    v_lshlrev_b32 v8, 4, v0
    s_lshl_b32 s9, s3, 10
    s_barrier
    s_waitcnt lgkmcnt(0)
    s_mov_b32 s40, s16
    s_mov_b32 s41, s17
    s_mov_b32 s42, 4096
    s_mov_b32 s43, 0x20000
    buffer_load_dwordx4 v[16:19], v8, s[40:43], s9 offen
    s_mov_b32 s44, s22
    s_mov_b32 s45, s23
    s_mov_b32 s46, 4194304
    s_mov_b32 s47, 0x20000
    s_mov_b32 s48, s28
    s_mov_b32 s49, s29
    s_mov_b32 s50, 1835008
    s_mov_b32 s51, 0x20000
    s_mov_b32 s52, s36
    s_mov_b32 s53, s37
    s_mov_b32 s54, 3145728
    s_mov_b32 s55, 0x20000
    s_and_b32 s14, s5, 3
    s_cmp_gt_u32 s4, 5
    s_cselect_b32 s9, 1, 0
    s_sub_u32 s9, s4, s9
    s_lshl_b32 s15, s9, 2
    s_add_u32 s15, s15, s6
    s_bfe_u32 s59, s5, 0x10002
    s_add_u32 s59, s59, 1
    s_cmp_lg_u32 s4, 5
    s_cselect_b32 s59, s59, 0
    s_bitcmp1_b32 s59, 0
    s_cselect_b32 s50, s50, 0
    v_lshlrev_b32 v9, 4, v5
    v_lshl_add_u32 v9, v6, 10, v9
    s_lshr_b32 s12, s5, 3
    s_and_b32 s13, s5, 7
    s_lshl_b32 s9, s12, 8
    s_lshl_b32 s10, s3, 6
    s_add_u32 s9, s9, s10
    buffer_load_dwordx4 v[32:35], v9, s[40:43], s9 offen
    s_lshl_b32 s9, s14, 8
    s_add_u32 s9, s9, s10
    buffer_load_dwordx4 v[36:39], v9, s[40:43], s9 offen
    v_lshrrev_b32 v10, 3, v0
    v_and_b32 v11, 7, v0
    v_lshlrev_b32 v11, 4, v11
    v_lshl_add_u32 v12, v10, 13, v11
    v_mul_u32_u24 v13, 3584, v10
    v_add_u32 v13, v13, v11
    s_lshl_b32 s9, s12, 7
    s_lshl_b32 s10, s3, 5
    s_add_u32 s9, s9, s10
    s_lshl_b32 s9, s9, 13
    s_lshl_b32 s10, s4, 10
    s_add_u32 s9, s9, s10
    s_lshl_b32 s10, s13, 7
    s_add_u32 s9, s9, s10
    s_lshl_b32 s11, s3, 12
    s_add_u32 s10, s11, 131072
    s_mov_b32 m0, s10
    s_add_u32 s10, s9, 0
    buffer_load_dwordx4 v12, s[44:47], s10 offen nt lds
    s_add_u32 s10, s11, 132096
    s_mov_b32 m0, s10
    s_add_u32 s10, s9, 65536
    buffer_load_dwordx4 v12, s[44:47], s10 offen nt lds
    s_add_u32 s10, s11, 133120
    s_mov_b32 m0, s10
    s_add_u32 s10, s9, 131072
    buffer_load_dwordx4 v12, s[44:47], s10 offen nt lds
    s_add_u32 s10, s11, 134144
    s_mov_b32 m0, s10
    s_add_u32 s10, s9, 196608
    buffer_load_dwordx4 v12, s[44:47], s10 offen nt lds
    s_lshl_b32 s9, s14, 7
    s_lshl_b32 s10, s3, 5
    s_add_u32 s9, s9, s10
    s_mul_i32 s9, s9, 3584
    s_lshl_b32 s10, s15, 7
    s_add_u32 s9, s9, s10
    s_lshl_b32 s11, s3, 12
    s_add_u32 s10, s11, 8192
    s_mov_b32 m0, s10
    s_add_u32 s10, s9, 0
    buffer_load_dwordx4 v13, s[48:51], s10 offen nt lds
    s_add_u32 s10, s11, 9216
    s_mov_b32 m0, s10
    s_add_u32 s10, s9, 28672
    buffer_load_dwordx4 v13, s[48:51], s10 offen nt lds
    s_add_u32 s10, s11, 10240
    s_mov_b32 m0, s10
    s_add_u32 s10, s9, 57344
    buffer_load_dwordx4 v13, s[48:51], s10 offen nt lds
    s_add_u32 s10, s11, 11264
    s_mov_b32 m0, s10
    s_add_u32 s10, s9, 86016
    buffer_load_dwordx4 v13, s[48:51], s10 offen nt lds
    s_cmp_eq_u32 s3, 0
    s_cbranch_scc0 Lc_79
    s_load_dword s38, s[36:37], 0
Lc_79:
    s_waitcnt vmcnt(8)
    v_lshlrev_b32 v64, 16, v16
    v_and_b32 v65, 0xffff0000, v16
    v_lshlrev_b32 v66, 16, v17
    v_and_b32 v67, 0xffff0000, v17
    v_lshlrev_b32 v68, 16, v18
    v_and_b32 v69, 0xffff0000, v18
    v_lshlrev_b32 v70, 16, v19
    v_and_b32 v71, 0xffff0000, v19
    v_pk_add_f32 v[40:41], v[64:65], v[66:67]
    v_pk_add_f32 v[42:43], v[68:69], v[70:71]
    v_pk_add_f32 v[40:41], v[40:41], v[42:43]
    v_add_f32 v40, v40, v41
    s_nop 1
    v_add_f32_dpp v40, v40, v40 quad_perm:[1,0,3,2] row_mask:0xf bank_mask:0xf
    s_nop 1
    v_add_f32_dpp v40, v40, v40 quad_perm:[2,3,0,1] row_mask:0xf bank_mask:0xf
    s_nop 1
    v_add_f32_dpp v40, v40, v40 row_ror:4 row_mask:0xf bank_mask:0xf
    s_nop 1
    v_add_f32_dpp v40, v40, v40 row_ror:8 row_mask:0xf bank_mask:0xf
    v_mov_b32 v41, v40
    s_nop 1
    v_permlane16_swap_b32 v40, v41
    v_add_f32 v40, v40, v41
    v_mov_b32 v41, v40
    s_nop 1
    v_permlane32_swap_b32 v40, v41
    v_add_f32 v40, v40, v41
    v_mul_f32 v40, 0x3b000000, v40
    v_sub_f32 v64, v64, v40
    v_sub_f32 v65, v65, v40
    v_sub_f32 v66, v66, v40
    v_sub_f32 v67, v67, v40
    v_sub_f32 v68, v68, v40
    v_sub_f32 v69, v69, v40
    v_sub_f32 v70, v70, v40
    v_sub_f32 v71, v71, v40
    v_mul_f32 v42, v64, v64
    v_mul_f32 v43, v65, v65
    v_fmac_f32 v42, v66, v66
    v_fmac_f32 v43, v67, v67
    v_fmac_f32 v42, v68, v68
    v_fmac_f32 v43, v69, v69
    v_fmac_f32 v42, v70, v70
    v_fmac_f32 v43, v71, v71
    v_add_f32 v42, v42, v43
    s_nop 1
    v_add_f32_dpp v42, v42, v42 quad_perm:[1,0,3,2] row_mask:0xf bank_mask:0xf
    s_nop 1
    v_add_f32_dpp v42, v42, v42 quad_perm:[2,3,0,1] row_mask:0xf bank_mask:0xf
    s_nop 1
    v_add_f32_dpp v42, v42, v42 row_ror:4 row_mask:0xf bank_mask:0xf
    s_nop 1
    v_add_f32_dpp v42, v42, v42 row_ror:8 row_mask:0xf bank_mask:0xf
    v_mov_b32 v41, v42
    s_nop 1
    v_permlane16_swap_b32 v42, v41
    v_add_f32 v42, v42, v41
    v_mov_b32 v41, v42
    s_nop 1
    v_permlane32_swap_b32 v42, v41
    v_add_f32 v42, v42, v41
    v_mul_f32 v42, 0x3b000000, v42
    v_cvt_pk_bf16_f32 v40, v40, v40
    v_lshlrev_b32 v40, 16, v40
    v_cvt_pk_bf16_f32 v42, v42, v42
    v_lshlrev_b32 v42, 16, v42
    v_add_f32 v42, 0x3727c5ac, v42
    v_cvt_pk_bf16_f32 v42, v42, v42
    v_lshlrev_b32 v42, 16, v42
    v_sqrt_f32 v42, v42
    s_nop 0
    v_cvt_pk_bf16_f32 v42, v42, v42
    v_lshlrev_b32 v42, 16, v42
    v_rcp_f32 v41, v42
    s_lshl_b32 s9, s3, 3
    s_add_u32 s9, s9, 162432
    v_mov_b32 v44, s9
    s_mov_b64 exec, 1
    ds_write_b64 v44, v[40:41]
    ds_add_u32 v2, v1 offset:80
    s_mov_b64 exec, -1
    v_lshlrev_b32 v44, 3, v6
    v_add_u32 v44, 162432, v44
    s_mov_b32 s60, 0
    s_mov_b64 exec, 1
Lw_80:
    ds_read_b32 v24, v2 offset:80
    s_waitcnt lgkmcnt(0)
    v_readfirstlane_b32 s62, v24
    s_cmp_ge_u32 s62, 4
    s_cbranch_scc1 Ld_81
    s_add_u32 s60, s60, 1
    s_cmp_lt_u32 s60, 4194304
    s_nop 0
    s_cbranch_scc1 Lw_80
    s_mov_b32 s61, 770
    s_branch L_fail
Ld_81:
    s_mov_b64 exec, -1
    ds_read_b64 v[40:41], v44
    s_waitcnt lgkmcnt(0)
    v_mov_b32 v42, v41
    v_lshlrev_b32 v44, 16, v32
    v_and_b32 v45, 0xffff0000, v32
    v_sub_f32 v44, v44, v40
    v_sub_f32 v45, v45, v40
    v_cvt_pk_bf16_f32 v46, v44, v45
    v_lshlrev_b32 v44, 16, v46
    v_and_b32 v45, 0xffff0000, v46
    v_mul_f32 v44, v44, v42
    v_mul_f32 v45, v45, v42
    v_cvt_pk_bf16_f32 v32, v44, v45
    v_lshlrev_b32 v44, 16, v33
    v_and_b32 v45, 0xffff0000, v33
    v_sub_f32 v44, v44, v40
    v_sub_f32 v45, v45, v40
    v_cvt_pk_bf16_f32 v46, v44, v45
    v_lshlrev_b32 v44, 16, v46
    v_and_b32 v45, 0xffff0000, v46
    v_mul_f32 v44, v44, v42
    v_mul_f32 v45, v45, v42
    v_cvt_pk_bf16_f32 v33, v44, v45
    v_lshlrev_b32 v44, 16, v34
    v_and_b32 v45, 0xffff0000, v34
    v_sub_f32 v44, v44, v40
    v_sub_f32 v45, v45, v40
    v_cvt_pk_bf16_f32 v46, v44, v45
    v_lshlrev_b32 v44, 16, v46
    v_and_b32 v45, 0xffff0000, v46
    v_mul_f32 v44, v44, v42
    v_mul_f32 v45, v45, v42
    v_cvt_pk_bf16_f32 v34, v44, v45
    v_lshlrev_b32 v44, 16, v35
    v_and_b32 v45, 0xffff0000, v35
    v_sub_f32 v44, v44, v40
    v_sub_f32 v45, v45, v40
    v_cvt_pk_bf16_f32 v46, v44, v45
    v_lshlrev_b32 v44, 16, v46
    v_and_b32 v45, 0xffff0000, v46
    v_mul_f32 v44, v44, v42
    v_mul_f32 v45, v45, v42
    v_cvt_pk_bf16_f32 v35, v44, v45
    v_lshlrev_b32 v44, 16, v36
    v_and_b32 v45, 0xffff0000, v36
    v_sub_f32 v44, v44, v40
    v_sub_f32 v45, v45, v40
    v_cvt_pk_bf16_f32 v46, v44, v45
    v_lshlrev_b32 v44, 16, v46
    v_and_b32 v45, 0xffff0000, v46
    v_mul_f32 v44, v44, v42
    v_mul_f32 v45, v45, v42
    v_cvt_pk_bf16_f32 v36, v44, v45
    v_lshlrev_b32 v44, 16, v37
    v_and_b32 v45, 0xffff0000, v37
    v_sub_f32 v44, v44, v40
    v_sub_f32 v45, v45, v40
    v_cvt_pk_bf16_f32 v46, v44, v45
    v_lshlrev_b32 v44, 16, v46
    v_and_b32 v45, 0xffff0000, v46
    v_mul_f32 v44, v44, v42
    v_mul_f32 v45, v45, v42
    v_cvt_pk_bf16_f32 v37, v44, v45
    v_lshlrev_b32 v44, 16, v38
    v_and_b32 v45, 0xffff0000, v38
    v_sub_f32 v44, v44, v40
    v_sub_f32 v45, v45, v40
    v_cvt_pk_bf16_f32 v46, v44, v45
    v_lshlrev_b32 v44, 16, v46
    v_and_b32 v45, 0xffff0000, v46
    v_mul_f32 v44, v44, v42
    v_mul_f32 v45, v45, v42
    v_cvt_pk_bf16_f32 v38, v44, v45
    v_lshlrev_b32 v44, 16, v39
    v_and_b32 v45, 0xffff0000, v39
    v_sub_f32 v44, v44, v40
    v_sub_f32 v45, v45, v40
    v_cvt_pk_bf16_f32 v46, v44, v45
    v_lshlrev_b32 v44, 16, v46
    v_and_b32 v45, 0xffff0000, v46
    v_mul_f32 v44, v44, v42
    v_mul_f32 v45, v45, v42
    v_cvt_pk_bf16_f32 v39, v44, v45
    v_lshlrev_b32 v15, 4, v0
    s_lshl_b32 s9, s3, 10
    s_add_u32 s9, s9, 0
    v_add_u32 v44, s9, v15
    ds_write_b128 v44, v[32:35]
    ds_write_b128 v44, v[36:39] offset:4096
    s_waitcnt vmcnt(4) lgkmcnt(0)
    s_cmp_eq_u32 s3, 0
    s_cbranch_scc0 Lc_82
    s_add_u32 s38, s38, 1
    s_and_b32 s39, s38, 1023
    v_mov_b32 v44, s39
    v_mov_b32 v45, s38
    ds_write_b64 v2, v[44:45] offset:56
    s_nop 0
Lc_82:
    s_mov_b64 exec, 1
    ds_add_u32 v2, v1 offset:0
    s_mov_b64 exec, -1
    s_mov_b32 s60, 0
    s_mov_b64 exec, 1
Lw_83:
    ds_read_b32 v24, v2 offset:0
    s_waitcnt lgkmcnt(0)
    v_readfirstlane_b32 s62, v24
    s_cmp_ge_u32 s62, 4
    s_cbranch_scc1 Ld_84
    s_add_u32 s60, s60, 1
    s_cmp_lt_u32 s60, 4194304
    s_nop 0
    s_cbranch_scc1 Lw_83
    s_mov_b32 s61, 769
    s_branch L_fail
Ld_84:
    s_mov_b64 exec, -1
    ds_read_b32 v14, v2 offset:56
    ds_read_b128 v[32:35], v15 offset:0
    ds_read_b128 v[36:39], v15 offset:1024
    ds_read_b128 v[40:43], v15 offset:2048
    ds_read_b128 v[44:47], v15 offset:3072
    ds_read_b128 v[48:51], v15 offset:4096
    ds_read_b128 v[52:55], v15 offset:5120
    ds_read_b128 v[56:59], v15 offset:6144
    ds_read_b128 v[60:63], v15 offset:7168
    v_lshrrev_b32 v8, 2, v4
    v_lshl_add_u32 v9, v5, 3, v8
    v_lshlrev_b32 v9, 7, v9
    v_lshl_add_u32 v9, v7, 3, v9
    s_lshl_b32 s9, s3, 5
    s_add_u32 s10, s9, 131072
    v_add_u32 v10, s10, v9
    s_add_u32 s10, s9, 8192
    v_add_u32 v11, s10, v9
    v_mov_b32 v13, v10
    ds_read_b64_tr_b16 v[64:65], v10 offset:0
    ds_read_b64_tr_b16 v[66:67], v10 offset:512
    ds_read_b64_tr_b16 v[68:69], v10 offset:4096
    ds_read_b64_tr_b16 v[70:71], v10 offset:4608
    ds_read_b64_tr_b16 v[72:73], v10 offset:8192
    ds_read_b64_tr_b16 v[74:75], v10 offset:8704
    ds_read_b64_tr_b16 v[76:77], v10 offset:12288
    ds_read_b64_tr_b16 v[78:79], v10 offset:12800
    s_waitcnt lgkmcnt(0)
    v_mfma_f32_16x16x32_bf16 v[96:99], v[64:67], v[32:35], 0
    v_mfma_f32_16x16x32_bf16 v[96:99], v[68:71], v[36:39], v[96:99]
    v_mfma_f32_16x16x32_bf16 v[96:99], v[72:75], v[40:43], v[96:99]
    v_mfma_f32_16x16x32_bf16 v[96:99], v[76:79], v[44:47], v[96:99]
    v_lshlrev_b32 v8, 13, v6
    v_lshl_add_u32 v8, v5, 4, v8
    s_lshl_b32 s9, s4, 15
    s_lshl_b32 s10, s12, 11
    s_add_u32 s9, s9, s10
    s_lshl_b32 s10, s13, 8
    s_add_u32 s9, s9, s10
    s_lshl_b32 s10, s3, 6
    s_add_u32 s9, s9, s10
    s_add_u32 s9, s9, 65536
    v_add_u32 v96, 0x200, v96
    v_add_u32 v97, 0x200, v97
    v_add_u32 v98, 0x200, v98
    v_add_u32 v99, 0x200, v99
    v_and_or_b32 v96, v96, s58, v14
    v_and_or_b32 v97, v97, s58, v14
    v_and_or_b32 v98, v98, s58, v14
    v_and_or_b32 v99, v99, s58, v14
    s_mov_b32 exec_lo, 0x11111111
    s_mov_b32 exec_hi, 0x11111111
    buffer_store_dwordx4 v[96:99], v8, s[52:55], s9 offen sc1
    s_mov_b64 exec, -1
    s_bitcmp1_b32 s59, 0
    s_cbranch_scc1 Lw1_86
    s_mov_b64 exec, 1
    ds_add_u32 v2, v1 offset:4
    s_mov_b64 exec, -1
    s_branch Lnh_85
Lw1_86:
    s_waitcnt vmcnt(1)
    s_mov_b64 exec, 1
    ds_add_u32 v2, v1 offset:88
    s_mov_b64 exec, -1
    s_mov_b32 s60, 0
    s_mov_b64 exec, 1
Lw_87:
    ds_read_b32 v24, v2 offset:88
    s_waitcnt lgkmcnt(0)
    v_readfirstlane_b32 s62, v24
    s_cmp_ge_u32 s62, 4
    s_cbranch_scc1 Ld_88
    s_add_u32 s60, s60, 1
    s_cmp_lt_u32 s60, 4194304
    s_nop 0
    s_cbranch_scc1 Lw_87
    s_mov_b32 s61, 771
    s_branch L_fail
Ld_88:
    s_mov_b64 exec, -1
    ds_read_b64_tr_b16 v[80:81], v11 offset:0
    ds_read_b64_tr_b16 v[82:83], v11 offset:512
    ds_read_b64_tr_b16 v[84:85], v11 offset:4096
    ds_read_b64_tr_b16 v[86:87], v11 offset:4608
    ds_read_b64_tr_b16 v[88:89], v11 offset:8192
    ds_read_b64_tr_b16 v[90:91], v11 offset:8704
    ds_read_b64_tr_b16 v[92:93], v11 offset:12288
    ds_read_b64_tr_b16 v[94:95], v11 offset:12800
    s_waitcnt lgkmcnt(0)
    s_mov_b64 exec, 1
    ds_add_u32 v2, v1 offset:4
    s_mov_b64 exec, -1
    v_mfma_f32_16x16x32_bf16 v[100:103], v[80:83], v[48:51], 0
    v_mfma_f32_16x16x32_bf16 v[100:103], v[84:87], v[52:55], v[100:103]
    v_mfma_f32_16x16x32_bf16 v[100:103], v[88:91], v[56:59], v[100:103]
    v_mfma_f32_16x16x32_bf16 v[100:103], v[92:95], v[60:63], v[100:103]
    v_lshlrev_b32 v9, 10, v6
    v_lshl_add_u32 v9, v5, 4, v9
    s_lshl_b32 s9, s15, 12
    s_lshl_b32 s10, s14, 8
    s_add_u32 s9, s9, s10
    s_lshl_b32 s10, s3, 6
    s_add_u32 s9, s9, s10
    s_add_u32 s9, s9, 393216
    v_add_u32 v100, 0x200, v100
    v_add_u32 v101, 0x200, v101
    v_add_u32 v102, 0x200, v102
    v_add_u32 v103, 0x200, v103
    v_and_or_b32 v100, v100, s58, v14
    v_and_or_b32 v101, v101, s58, v14
    v_and_or_b32 v102, v102, s58, v14
    v_and_or_b32 v103, v103, s58, v14
    s_mov_b32 exec_lo, 0x11111111
    s_mov_b32 exec_hi, 0x11111111
    buffer_store_dwordx4 v[100:103], v9, s[52:55], s9 offen sc1
    s_mov_b64 exec, -1
    s_nop 0
Lnh_85:
    s_mov_b32 s56, 0xaaaaaaaa
    s_mov_b32 s57, 0xaaaaaaaa
    s_cmp_eq_u32 s3, 1
    s_cbranch_scc1 L_aux1
    s_cmp_eq_u32 s3, 2
    s_cbranch_scc1 L_aux2
    s_cmp_eq_u32 s3, 3
    s_cbranch_scc1 L_aux3
    s_mov_b32 s60, 0
    s_mov_b64 exec, 1
Lw_89:
    ds_read_b32 v24, v2 offset:12
    s_waitcnt lgkmcnt(0)
    v_readfirstlane_b32 s62, v24
    s_cmp_ge_u32 s62, 1
    s_cbranch_scc1 Ld_90
    s_sleep 4
    s_add_u32 s60, s60, 1
    s_cmp_lt_u32 s60, 4194304
    s_cbranch_scc1 Lw_89
    s_mov_b32 s61, 784
    s_branch L_fail
Ld_90:
    s_mov_b64 exec, -1
    s_lshl_b32 s9, s4, 2
    s_add_u32 s9, s9, s6
    s_lshl_b32 s9, s9, 13
    s_add_u32 s9, s9, 65536
    s_add_u32 s10, s9, 4096
    v_lshlrev_b32 v18, 4, v0
    s_mov_b32 s60, 0
    s_nop 0
Lg_91:
    buffer_load_dwordx4 v[64:67], v18, s[52:55], s9 offen offset:0 sc1
    buffer_load_dwordx4 v[68:71], v18, s[52:55], s9 offen offset:1024 sc1
    buffer_load_dwordx4 v[72:75], v18, s[52:55], s9 offen offset:2048 sc1
    buffer_load_dwordx4 v[76:79], v18, s[52:55], s9 offen offset:3072 sc1
    buffer_load_dwordx4 v[80:83], v18, s[52:55], s10 offen offset:0 sc1
    buffer_load_dwordx4 v[84:87], v18, s[52:55], s10 offen offset:1024 sc1
    buffer_load_dwordx4 v[88:91], v18, s[52:55], s10 offen offset:2048 sc1
    buffer_load_dwordx4 v[92:95], v18, s[52:55], s10 offen offset:3072 sc1
    s_waitcnt vmcnt(0)
    v_xor_b32 v64, v14, v64
    v_xor_b32 v65, v14, v65
    v_xor_b32 v66, v14, v66
    v_xor_b32 v67, v14, v67
    v_xor_b32 v68, v14, v68
    v_xor_b32 v69, v14, v69
    v_xor_b32 v70, v14, v70
    v_xor_b32 v71, v14, v71
    v_xor_b32 v72, v14, v72
    v_xor_b32 v73, v14, v73
    v_xor_b32 v74, v14, v74
    v_xor_b32 v75, v14, v75
    v_xor_b32 v76, v14, v76
    v_xor_b32 v77, v14, v77
    v_xor_b32 v78, v14, v78
    v_xor_b32 v79, v14, v79
    v_xor_b32 v80, v14, v80
    v_xor_b32 v81, v14, v81
    v_xor_b32 v82, v14, v82
    v_xor_b32 v83, v14, v83
    v_xor_b32 v84, v14, v84
    v_xor_b32 v85, v14, v85
    v_xor_b32 v86, v14, v86
    v_xor_b32 v87, v14, v87
    v_xor_b32 v88, v14, v88
    v_xor_b32 v89, v14, v89
    v_xor_b32 v90, v14, v90
    v_xor_b32 v91, v14, v91
    v_xor_b32 v92, v14, v92
    v_xor_b32 v93, v14, v93
    v_xor_b32 v94, v14, v94
    v_xor_b32 v95, v14, v95
    v_or3_b32 v41, v64, v65, v66
    v_or3_b32 v41, v67, v68, v41
    v_or3_b32 v41, v69, v70, v41
    v_or3_b32 v41, v71, v72, v41
    v_or3_b32 v41, v73, v74, v41
    v_or3_b32 v41, v75, v76, v41
    v_or3_b32 v41, v77, v78, v41
    v_or3_b32 v41, v79, v80, v41
    v_or3_b32 v41, v81, v82, v41
    v_or3_b32 v41, v83, v84, v41
    v_or3_b32 v41, v85, v86, v41
    v_or3_b32 v41, v87, v88, v41
    v_or3_b32 v41, v89, v90, v41
    v_or3_b32 v41, v91, v92, v41
    v_or3_b32 v41, v93, v94, v41
    v_or_b32 v41, v95, v41
    v_and_b32 v41, 1023, v41
    v_cmp_ne_u32 vcc, 0, v41
    s_cmp_eq_u64 vcc, 0
    s_cbranch_scc1 Ld_92
    s_mov_b64 exec, vcc
    s_sleep 4
    s_add_u32 s60, s60, 1
    s_cmp_lt_u32 s60, 1048576
    s_cbranch_scc1 Lg_91
    s_mov_b64 exec, -1
    s_mov_b32 s61, 785
    s_branch L_fail
Ld_92:
    s_mov_b64 exec, -1
    v_pk_add_f32 v[64:65], v[64:65], v[72:73]
    v_pk_add_f32 v[80:81], v[80:81], v[88:89]
    v_pk_add_f32 v[66:67], v[66:67], v[74:75]
    v_pk_add_f32 v[82:83], v[82:83], v[90:91]
    v_pk_add_f32 v[68:69], v[68:69], v[76:77]
    v_pk_add_f32 v[84:85], v[84:85], v[92:93]
    v_pk_add_f32 v[70:71], v[70:71], v[78:79]
    v_pk_add_f32 v[86:87], v[86:87], v[94:95]
    v_pk_add_f32 v[64:65], v[64:65], v[80:81]
    v_pk_add_f32 v[66:67], v[66:67], v[82:83]
    v_pk_add_f32 v[68:69], v[68:69], v[84:85]
    v_pk_add_f32 v[70:71], v[70:71], v[86:87]
    v_cvt_pk_bf16_f32 v40, v64, v65
    v_cvt_pk_bf16_f32 v41, v66, v67
    v_cvt_pk_bf16_f32 v42, v68, v69
    v_cvt_pk_bf16_f32 v43, v70, v71
    v_lshlrev_b32 v18, 3, v0
    v_add_u32 v18, 160000, v18
    ds_write_b64 v18, v[40:41]
    ds_write_b64 v18, v[42:43] offset:512
    s_mov_b64 exec, 1
    ds_write_b32 v2, v1 offset:16
    s_mov_b64 exec, -1
    s_branch L_wo
L_aux1:
    s_bitcmp1_b32 s59, 1
    s_cbranch_scc1 Lw2_93
    s_mov_b64 exec, 1
    ds_write_b32 v2, v1 offset:84
    s_mov_b64 exec, -1
    s_branch L_wo
Lw2_93:
    s_mov_b32 s48, s30
    s_mov_b32 s49, s31
    s_mov_b32 s50, 1835008
    s_mov_b32 s51, 0x20000
    v_lshrrev_b32 v18, 4, v0
    v_and_b32 v19, 15, v0
    v_lshlrev_b32 v20, 1, v18
    v_xor_b32 v20, v20, v19
    v_lshlrev_b32 v20, 4, v20
    v_lshl_add_u32 v20, v18, 10, v20
    v_or_b32 v21, 4, v18
    v_lshlrev_b32 v21, 1, v21
    v_xor_b32 v21, v21, v19
    v_lshlrev_b32 v21, 4, v21
    v_lshl_add_u32 v21, v18, 10, v21
    s_lshl_b32 s9, s15, 16
    s_lshl_b32 s10, s14, 8
    s_add_u32 s9, s9, s10
    s_mov_b32 s60, 0
    s_mov_b64 exec, 1
Lw_94:
    ds_read_b32 v24, v2 offset:4
    s_waitcnt lgkmcnt(0)
    v_readfirstlane_b32 s62, v24
    s_cmp_ge_u32 s62, 4
    s_cbranch_scc1 Ld_95
    s_sleep 1
    s_add_u32 s60, s60, 1
    s_cmp_lt_u32 s60, 4194304
    s_cbranch_scc1 Lw_94
    s_mov_b32 s61, 803
    s_branch L_fail
Ld_95:
    s_mov_b64 exec, -1
    s_mov_b32 m0, 131072
    s_add_u32 s10, s9, 0
    buffer_load_dwordx4 v20, s[48:51], s10 offen nt lds
    s_mov_b32 m0, 132096
    s_add_u32 s10, s9, 4096
    buffer_load_dwordx4 v20, s[48:51], s10 offen nt lds
    s_mov_b32 m0, 133120
    s_add_u32 s10, s9, 8192
    buffer_load_dwordx4 v21, s[48:51], s10 offen nt lds
    s_mov_b32 m0, 134144
    s_add_u32 s10, s9, 12288
    buffer_load_dwordx4 v21, s[48:51], s10 offen nt lds
    s_mov_b32 m0, 135168
    s_add_u32 s10, s9, 16384
    buffer_load_dwordx4 v20, s[48:51], s10 offen nt lds
    s_mov_b32 m0, 136192
    s_add_u32 s10, s9, 20480
    buffer_load_dwordx4 v20, s[48:51], s10 offen nt lds
    s_mov_b32 m0, 137216
    s_add_u32 s10, s9, 24576
    buffer_load_dwordx4 v21, s[48:51], s10 offen nt lds
    s_mov_b32 m0, 138240
    s_add_u32 s10, s9, 28672
    buffer_load_dwordx4 v21, s[48:51], s10 offen nt lds
    s_mov_b32 m0, 139264
    s_add_u32 s10, s9, 32768
    buffer_load_dwordx4 v20, s[48:51], s10 offen nt lds
    s_mov_b32 m0, 140288
    s_add_u32 s10, s9, 36864
    buffer_load_dwordx4 v20, s[48:51], s10 offen nt lds
    s_mov_b32 m0, 141312
    s_add_u32 s10, s9, 40960
    buffer_load_dwordx4 v21, s[48:51], s10 offen nt lds
    s_mov_b32 m0, 142336
    s_add_u32 s10, s9, 45056
    buffer_load_dwordx4 v21, s[48:51], s10 offen nt lds
    s_mov_b32 m0, 143360
    s_add_u32 s10, s9, 49152
    buffer_load_dwordx4 v20, s[48:51], s10 offen nt lds
    s_mov_b32 m0, 144384
    s_add_u32 s10, s9, 53248
    buffer_load_dwordx4 v20, s[48:51], s10 offen nt lds
    s_mov_b32 m0, 145408
    s_add_u32 s10, s9, 57344
    buffer_load_dwordx4 v21, s[48:51], s10 offen nt lds
    s_mov_b32 m0, 146432
    s_add_u32 s10, s9, 61440
    buffer_load_dwordx4 v21, s[48:51], s10 offen nt lds
    v_lshrrev_b32 v16, 2, v4
    v_and_b32 v17, 1, v5
    v_lshl_add_u32 v17, v17, 2, v16
    v_lshl_add_u32 v22, v5, 3, v16
    v_lshlrev_b32 v22, 8, v22
    v_lshl_add_u32 v22, v17, 5, v22
    v_lshl_add_u32 v22, v7, 3, v22
    v_lshlrev_b32 v23, 4, v0
    s_lshl_b32 s87, s15, 12
    s_add_u32 s87, s87, 393216
    v_lshrrev_b32 v28, 5, v0
    v_bfe_u32 v16, v0, 4, 1
    v_lshl_add_u32 v28, v16, 1, v28
    v_lshlrev_b32 v28, 7, v28
    v_and_b32 v16, 15, v0
    v_lshl_add_u32 v28, v16, 3, v28
    v_add_u32 v28, 161920, v28
    v_lshlrev_b32 v29, 7, v6
    v_lshl_add_u32 v29, v5, 4, v29
    v_add_u32 v29, 161920, v29
    v_lshlrev_b32 v19, 1, v7
    v_lshrrev_b32 v20, 1, v5
    v_add_u32 v19, v19, v20
    v_lshlrev_b32 v19, 12, v19
    v_lshl_add_u32 v19, v6, 5, v19
    v_and_b32 v20, 1, v5
    v_lshl_add_u32 v19, v20, 4, v19
    s_lshl_b32 s88, s14, 16
    s_lshl_b32 s89, s15, 7
    s_add_u32 s88, s88, s89
    s_add_u32 s88, s88, 1310720
    s_waitcnt vmcnt(0)
    v_xor_b32 v18, 0, v22
    v_add_u32 v18, 131072, v18
    ds_read_b64_tr_b16 v[64:65], v18
    ds_read_b64_tr_b16 v[66:67], v18 offset:1024
    v_xor_b32 v18, 32, v22
    v_add_u32 v18, 131072, v18
    ds_read_b64_tr_b16 v[68:69], v18
    ds_read_b64_tr_b16 v[70:71], v18 offset:1024
    v_xor_b32 v18, 64, v22
    v_add_u32 v18, 131072, v18
    ds_read_b64_tr_b16 v[72:73], v18
    ds_read_b64_tr_b16 v[74:75], v18 offset:1024
    v_xor_b32 v18, 96, v22
    v_add_u32 v18, 131072, v18
    ds_read_b64_tr_b16 v[76:77], v18
    ds_read_b64_tr_b16 v[78:79], v18 offset:1024
    v_xor_b32 v18, 128, v22
    v_add_u32 v18, 131072, v18
    ds_read_b64_tr_b16 v[80:81], v18
    ds_read_b64_tr_b16 v[82:83], v18 offset:1024
    v_xor_b32 v18, 160, v22
    v_add_u32 v18, 131072, v18
    ds_read_b64_tr_b16 v[84:85], v18
    ds_read_b64_tr_b16 v[86:87], v18 offset:1024
    v_xor_b32 v18, 192, v22
    v_add_u32 v18, 131072, v18
    ds_read_b64_tr_b16 v[88:89], v18
    ds_read_b64_tr_b16 v[90:91], v18 offset:1024
    v_xor_b32 v18, 224, v22
    v_add_u32 v18, 131072, v18
    ds_read_b64_tr_b16 v[92:93], v18
    ds_read_b64_tr_b16 v[94:95], v18 offset:1024
    v_xor_b32 v18, 0, v22
    v_add_u32 v18, 139264, v18
    ds_read_b64_tr_b16 v[96:97], v18
    ds_read_b64_tr_b16 v[98:99], v18 offset:1024
    v_xor_b32 v18, 32, v22
    v_add_u32 v18, 139264, v18
    ds_read_b64_tr_b16 v[100:101], v18
    ds_read_b64_tr_b16 v[102:103], v18 offset:1024
    v_xor_b32 v18, 64, v22
    v_add_u32 v18, 139264, v18
    ds_read_b64_tr_b16 v[104:105], v18
    ds_read_b64_tr_b16 v[106:107], v18 offset:1024
    v_xor_b32 v18, 96, v22
    v_add_u32 v18, 139264, v18
    ds_read_b64_tr_b16 v[108:109], v18
    ds_read_b64_tr_b16 v[110:111], v18 offset:1024
    v_xor_b32 v18, 128, v22
    v_add_u32 v18, 139264, v18
    ds_read_b64_tr_b16 v[112:113], v18
    ds_read_b64_tr_b16 v[114:115], v18 offset:1024
    v_xor_b32 v18, 160, v22
    v_add_u32 v18, 139264, v18
    ds_read_b64_tr_b16 v[116:117], v18
    ds_read_b64_tr_b16 v[118:119], v18 offset:1024
    v_xor_b32 v18, 192, v22
    v_add_u32 v18, 139264, v18
    ds_read_b64_tr_b16 v[120:121], v18
    ds_read_b64_tr_b16 v[122:123], v18 offset:1024
    v_xor_b32 v18, 224, v22
    v_add_u32 v18, 139264, v18
    ds_read_b64_tr_b16 v[124:125], v18
    ds_read_b64_tr_b16 v[126:127], v18 offset:1024
    s_waitcnt lgkmcnt(0)
    s_mov_b64 exec, 1
    ds_write_b32 v2, v1 offset:84
    s_mov_b64 exec, -1
    s_mov_b32 s60, 0
    s_mov_b64 exec, 1
Lp_96:
    ds_read_b128 v[24:27], v2 offset:32
    s_waitcnt lgkmcnt(0)
    v_min_u32 v24, v24, v25
    v_min3_u32 v24, v24, v26, v27
    s_nop 0
    v_readfirstlane_b32 s62, v24
    s_cmp_ge_u32 s62, 6
    s_cbranch_scc1 Ld_97
    s_sleep 4
    s_add_u32 s60, s60, 1
    s_cmp_lt_u32 s60, 4194304
    s_cbranch_scc1 Lp_96
    s_mov_b32 s61, 800
    s_branch L_fail
Ld_97:
    s_mov_b64 exec, -1
    s_mov_b32 s60, 0
Lg_98:
    buffer_load_dwordx4 v[32:35], v23, s[52:55], s87 offen offset:0 sc1
    buffer_load_dwordx4 v[36:39], v23, s[52:55], s87 offen offset:1024 sc1
    buffer_load_dwordx4 v[40:43], v23, s[52:55], s87 offen offset:2048 sc1
    buffer_load_dwordx4 v[44:47], v23, s[52:55], s87 offen offset:3072 sc1
    s_waitcnt vmcnt(0)
    v_xor_b32 v32, v14, v32
    v_xor_b32 v33, v14, v33
    v_xor_b32 v34, v14, v34
    v_xor_b32 v35, v14, v35
    v_xor_b32 v36, v14, v36
    v_xor_b32 v37, v14, v37
    v_xor_b32 v38, v14, v38
    v_xor_b32 v39, v14, v39
    v_xor_b32 v40, v14, v40
    v_xor_b32 v41, v14, v41
    v_xor_b32 v42, v14, v42
    v_xor_b32 v43, v14, v43
    v_xor_b32 v44, v14, v44
    v_xor_b32 v45, v14, v45
    v_xor_b32 v46, v14, v46
    v_xor_b32 v47, v14, v47
    v_or3_b32 v30, v32, v33, v34
    v_or3_b32 v30, v35, v36, v30
    v_or3_b32 v30, v37, v38, v30
    v_or3_b32 v30, v39, v40, v30
    v_or3_b32 v30, v41, v42, v30
    v_or3_b32 v30, v43, v44, v30
    v_or3_b32 v30, v45, v46, v30
    v_or_b32 v30, v47, v30
    v_and_b32 v30, 1023, v30
    v_cmp_ne_u32 vcc, 0, v30
    s_cmp_eq_u64 vcc, 0
    s_cbranch_scc1 Ld_99
    s_mov_b64 exec, vcc
    s_sleep 8
    s_add_u32 s60, s60, 1
    s_cmp_lt_u32 s60, 1048576
    s_cbranch_scc1 Lg_98
    s_mov_b64 exec, -1
    s_mov_b32 s61, 801
    s_branch L_fail
Ld_99:
    s_mov_b64 exec, -1
    v_permlane32_swap_b32 v32, v36
    v_permlane32_swap_b32 v40, v44
    v_permlane32_swap_b32 v33, v37
    v_permlane32_swap_b32 v41, v45
    v_permlane32_swap_b32 v34, v38
    v_permlane32_swap_b32 v42, v46
    v_permlane32_swap_b32 v35, v39
    v_permlane32_swap_b32 v43, v47
    v_pk_add_f32 v[32:33], v[32:33], v[36:37]
    v_pk_add_f32 v[40:41], v[40:41], v[44:45]
    v_pk_add_f32 v[34:35], v[34:35], v[38:39]
    v_pk_add_f32 v[42:43], v[42:43], v[46:47]
    v_permlane16_swap_b32 v32, v40
    v_permlane16_swap_b32 v33, v41
    v_permlane16_swap_b32 v34, v42
    v_permlane16_swap_b32 v35, v43
    v_pk_add_f32 v[32:33], v[32:33], v[40:41]
    v_pk_add_f32 v[34:35], v[34:35], v[42:43]
    v_max_f32 v32, 0, v32
    v_max_f32 v33, 0, v33
    v_max_f32 v34, 0, v34
    v_max_f32 v35, 0, v35
    v_cvt_pk_bf16_f32 v36, v32, v33
    v_cvt_pk_bf16_f32 v37, v34, v35
    ds_write_b64 v28, v[36:37]
    ds_read_b128 v[40:43], v29
    ds_read_b128 v[44:47], v29 offset:64
    s_mov_b32 s62, 0xcccccccc
    s_mov_b32 s63, 0xcccccccc
    s_waitcnt lgkmcnt(0)
    v_mfma_f32_16x16x32_bf16 v[48:51], v[64:67], v[40:43], 0
    v_mfma_f32_16x16x32_bf16 v[52:55], v[68:71], v[40:43], 0
    v_mfma_f32_16x16x32_bf16 v[56:59], v[72:75], v[40:43], 0
    v_mfma_f32_16x16x32_bf16 v[60:63], v[76:79], v[40:43], 0
    v_mfma_f32_16x16x32_bf16 v[48:51], v[96:99], v[44:47], v[48:51]
    v_mfma_f32_16x16x32_bf16 v[52:55], v[100:103], v[44:47], v[52:55]
    v_mfma_f32_16x16x32_bf16 v[56:59], v[104:107], v[44:47], v[56:59]
    v_mfma_f32_16x16x32_bf16 v[60:63], v[108:111], v[44:47], v[60:63]
    s_nop 5
    v_cndmask_b32 v32, v48, v52, s[56:57]
    v_cndmask_b32 v33, v49, v53, s[56:57]
    v_cndmask_b32 v34, v50, v54, s[56:57]
    v_cndmask_b32 v35, v51, v55, s[56:57]
    v_cndmask_b32 v48, v56, v60, s[56:57]
    v_cndmask_b32 v49, v57, v61, s[56:57]
    v_cndmask_b32 v50, v58, v62, s[56:57]
    v_cndmask_b32 v51, v59, v63, s[56:57]
    v_cndmask_b32 v32, v32, v48, s[62:63]
    v_cndmask_b32 v33, v33, v49, s[62:63]
    v_cndmask_b32 v34, v34, v50, s[62:63]
    v_cndmask_b32 v35, v35, v51, s[62:63]
    v_add_u32 v32, 0x200, v32
    v_add_u32 v33, 0x200, v33
    v_add_u32 v34, 0x200, v34
    v_add_u32 v35, 0x200, v35
    v_and_or_b32 v32, v32, s58, v14
    v_and_or_b32 v33, v33, s58, v14
    v_and_or_b32 v34, v34, s58, v14
    v_and_or_b32 v35, v35, s58, v14
    buffer_store_dwordx4 v[32:35], v19, s[52:55], s88 offen sc1
    v_mfma_f32_16x16x32_bf16 v[48:51], v[80:83], v[40:43], 0
    v_mfma_f32_16x16x32_bf16 v[52:55], v[84:87], v[40:43], 0
    v_mfma_f32_16x16x32_bf16 v[56:59], v[88:91], v[40:43], 0
    v_mfma_f32_16x16x32_bf16 v[60:63], v[92:95], v[40:43], 0
    v_mfma_f32_16x16x32_bf16 v[48:51], v[112:115], v[44:47], v[48:51]
    v_mfma_f32_16x16x32_bf16 v[52:55], v[116:119], v[44:47], v[52:55]
    v_mfma_f32_16x16x32_bf16 v[56:59], v[120:123], v[44:47], v[56:59]
    v_mfma_f32_16x16x32_bf16 v[60:63], v[124:127], v[44:47], v[60:63]
    s_nop 5
    v_cndmask_b32 v32, v48, v52, s[56:57]
    v_cndmask_b32 v33, v49, v53, s[56:57]
    v_cndmask_b32 v34, v50, v54, s[56:57]
    v_cndmask_b32 v35, v51, v55, s[56:57]
    v_cndmask_b32 v48, v56, v60, s[56:57]
    v_cndmask_b32 v49, v57, v61, s[56:57]
    v_cndmask_b32 v50, v58, v62, s[56:57]
    v_cndmask_b32 v51, v59, v63, s[56:57]
    v_cndmask_b32 v32, v32, v48, s[62:63]
    v_cndmask_b32 v33, v33, v49, s[62:63]
    v_cndmask_b32 v34, v34, v50, s[62:63]
    v_cndmask_b32 v35, v35, v51, s[62:63]
    v_add_u32 v32, 0x200, v32
    v_add_u32 v33, 0x200, v33
    v_add_u32 v34, 0x200, v34
    v_add_u32 v35, 0x200, v35
    v_and_or_b32 v32, v32, s58, v14
    v_and_or_b32 v33, v33, s58, v14
    v_and_or_b32 v34, v34, s58, v14
    v_and_or_b32 v35, v35, s58, v14
    s_add_u32 s88, s88, 0x8000
    buffer_store_dwordx4 v[32:35], v19, s[52:55], s88 offen sc1
    s_nop 1
    s_branch L_wo
L_aux2:
    s_mov_b32 s60, 0
    s_mov_b64 exec, 1
Lw_100:
    ds_read_b32 v24, v2 offset:24
    s_waitcnt lgkmcnt(0)
    v_readfirstlane_b32 s62, v24
    s_cmp_ge_u32 s62, 8
    s_cbranch_scc1 Ld_101
    s_sleep 4
    s_add_u32 s60, s60, 1
    s_cmp_lt_u32 s60, 4194304
    s_cbranch_scc1 Lw_100
    s_mov_b32 s61, 816
    s_branch L_fail
Ld_101:
    s_mov_b64 exec, -1
    v_mov_b32 v18, 161024
    ds_read_b128 v[64:67], v18 offset:0
    ds_read_b128 v[68:71], v18 offset:16
    ds_read_b128 v[96:99], v18 offset:128
    ds_read_b128 v[100:103], v18 offset:144
    ds_read_b128 v[72:75], v18 offset:32
    ds_read_b128 v[76:79], v18 offset:48
    ds_read_b128 v[104:107], v18 offset:160
    ds_read_b128 v[108:111], v18 offset:176
    ds_read_b128 v[80:83], v18 offset:64
    ds_read_b128 v[84:87], v18 offset:80
    ds_read_b128 v[112:115], v18 offset:192
    ds_read_b128 v[116:119], v18 offset:208
    ds_read_b128 v[88:91], v18 offset:96
    ds_read_b128 v[92:95], v18 offset:112
    ds_read_b128 v[120:123], v18 offset:224
    ds_read_b128 v[124:127], v18 offset:240
    s_waitcnt lgkmcnt(0)
    v_max3_f32 v44, v64, v65, v66
    v_max3_f32 v44, v44, v67, v68
    v_max3_f32 v44, v44, v69, v70
    v_max_f32 v44, v44, v71
    v_add_f32 v48, v96, v97
    v_add_f32 v48, v48, v98
    v_add_f32 v48, v48, v99
    v_add_f32 v48, v48, v100
    v_add_f32 v48, v48, v101
    v_add_f32 v48, v48, v102
    v_add_f32 v48, v48, v103
    v_max3_f32 v45, v72, v73, v74
    v_max3_f32 v45, v45, v75, v76
    v_max3_f32 v45, v45, v77, v78
    v_max_f32 v45, v45, v79
    v_add_f32 v49, v104, v105
    v_add_f32 v49, v49, v106
    v_add_f32 v49, v49, v107
    v_add_f32 v49, v49, v108
    v_add_f32 v49, v49, v109
    v_add_f32 v49, v49, v110
    v_add_f32 v49, v49, v111
    v_max3_f32 v46, v80, v81, v82
    v_max3_f32 v46, v46, v83, v84
    v_max3_f32 v46, v46, v85, v86
    v_max_f32 v46, v46, v87
    v_add_f32 v50, v112, v113
    v_add_f32 v50, v50, v114
    v_add_f32 v50, v50, v115
    v_add_f32 v50, v50, v116
    v_add_f32 v50, v50, v117
    v_add_f32 v50, v50, v118
    v_add_f32 v50, v50, v119
    v_max3_f32 v47, v88, v89, v90
    v_max3_f32 v47, v47, v91, v92
    v_max3_f32 v47, v47, v93, v94
    v_max_f32 v47, v47, v95
    v_add_f32 v51, v120, v121
    v_add_f32 v51, v51, v122
    v_add_f32 v51, v51, v123
    v_add_f32 v51, v51, v124
    v_add_f32 v51, v51, v125
    v_add_f32 v51, v51, v126
    v_add_f32 v51, v51, v127
    v_cndmask_b32 v52, v44, v48, s[56:57]
    v_cndmask_b32 v53, v45, v49, s[56:57]
    v_cndmask_b32 v54, v46, v50, s[56:57]
    v_cndmask_b32 v55, v47, v51, s[56:57]
    v_add_u32 v52, 0x200, v52
    v_add_u32 v53, 0x200, v53
    v_add_u32 v54, 0x200, v54
    v_add_u32 v55, 0x200, v55
    v_and_or_b32 v52, v52, s58, v14
    v_and_or_b32 v53, v53, s58, v14
    v_and_or_b32 v54, v54, s58, v14
    v_and_or_b32 v55, v55, s58, v14
    s_lshl_b32 s9, s4, 10
    s_add_u32 s9, s9, 655360
    s_lshl_b32 s10, s5, 5
    s_add_u32 s10, s10, s9
    v_lshlrev_b32 v18, 4, v0
    s_mov_b64 exec, 3
    buffer_store_dwordx4 v[52:55], v18, s[52:55], s10 offen sc1
    s_mov_b64 exec, -1
    s_mov_b32 s60, 0
    s_mov_b64 exec, 1
Lp_102:
    ds_read_b128 v[24:27], v2 offset:32
    s_waitcnt lgkmcnt(0)
    v_min_u32 v24, v24, v25
    v_min3_u32 v24, v24, v26, v27
    s_nop 0
    v_readfirstlane_b32 s62, v24
    s_cmp_ge_u32 s62, 10
    s_cbranch_scc1 Ld_103
    s_sleep 4
    s_add_u32 s60, s60, 1
    s_cmp_lt_u32 s60, 4194304
    s_cbranch_scc1 Lp_102
    s_mov_b32 s61, 818
    s_branch L_fail
Ld_103:
    s_mov_b64 exec, -1
    s_mov_b32 s60, 0
Lg_104:
    buffer_load_dwordx4 v[64:67], v18, s[52:55], s9 offen sc1
    s_waitcnt vmcnt(0)
    v_xor_b32 v64, v14, v64
    v_xor_b32 v65, v14, v65
    v_xor_b32 v66, v14, v66
    v_xor_b32 v67, v14, v67
    v_or3_b32 v41, v64, v65, v66
    v_or_b32 v41, v67, v41
    v_and_b32 v41, 1023, v41
    v_cmp_ne_u32 vcc, 0, v41
    s_cmp_eq_u64 vcc, 0
    s_cbranch_scc1 Ld_105
    s_mov_b64 exec, vcc
    s_sleep 8
    s_add_u32 s60, s60, 1
    s_cmp_lt_u32 s60, 1048576
    s_cbranch_scc1 Lg_104
    s_mov_b64 exec, -1
    s_mov_b32 s61, 817
    s_branch L_fail
Ld_105:
    s_mov_b64 exec, -1
    s_cmp_eq_u32 s6, 1
    s_cselect_b64 s[62:63], -1, 0
    v_cndmask_b32 v64, v64, v65, s[62:63]
    s_cmp_eq_u32 s6, 2
    s_cselect_b64 s[62:63], -1, 0
    v_cndmask_b32 v64, v64, v66, s[62:63]
    s_cmp_eq_u32 s6, 3
    s_cselect_b64 s[62:63], -1, 0
    v_cndmask_b32 v64, v64, v67, s[62:63]
    s_nop 1
    v_mov_b32_dpp v65, v64 quad_perm:[1,0,3,2] row_mask:0xf bank_mask:0xf
    v_cndmask_b32 v66, v64, v65, s[56:57]
    v_cndmask_b32 v67, v65, v64, s[56:57]
    v_mov_b32 v68, v66
    s_nop 1
    v_max_f32_dpp v68, v68, v68 quad_perm:[2,3,0,1] row_mask:0xf bank_mask:0xf
    s_nop 1
    v_max_f32_dpp v68, v68, v68 row_ror:4 row_mask:0xf bank_mask:0xf
    s_nop 1
    v_max_f32_dpp v68, v68, v68 row_ror:8 row_mask:0xf bank_mask:0xf
    v_sub_f32 v66, v66, v68
    v_mul_f32 v66, 0x3fb8aa3b, v66
    v_exp_f32 v66, v66
    s_nop 0
    v_mul_f32 v67, v66, v67
    s_nop 1
    v_add_f32_dpp v67, v67, v67 quad_perm:[2,3,0,1] row_mask:0xf bank_mask:0xf
    s_nop 1
    v_add_f32_dpp v67, v67, v67 row_ror:4 row_mask:0xf bank_mask:0xf
    s_nop 1
    v_add_f32_dpp v67, v67, v67 row_ror:8 row_mask:0xf bank_mask:0xf
    v_rcp_f32 v67, v67
    s_nop 0
    v_mul_f32 v66, v66, v67
    v_lshrrev_b32 v18, 1, v0
    v_lshlrev_b32 v18, 2, v18
    v_add_u32 v18, 161280, v18
    ds_write_b32 v18, v66
    s_mov_b64 exec, 1
    ds_write_b32 v2, v1 offset:28
    s_mov_b64 exec, -1
    s_branch L_wo
L_aux3:
    s_getreg_b32 s12, hwreg(HW_REG_XCC_ID, 0, 4)
    s_lshl_b32 s12, s12, 16
    v_mov_b32 v64, s12
    v_mov_b32 v65, s12
    v_mov_b32 v66, s12
    v_mov_b32 v67, s12
    v_add_u32 v64, 0x200, v64
    v_add_u32 v65, 0x200, v65
    v_add_u32 v66, 0x200, v66
    v_add_u32 v67, 0x200, v67
    v_and_or_b32 v64, v64, s58, v14
    v_and_or_b32 v65, v65, s58, v14
    v_and_or_b32 v66, v66, s58, v14
    v_and_or_b32 v67, v67, s58, v14
    s_lshl_b32 s9, s4, 9
    s_add_u32 s9, s9, 2359296
    s_lshl_b32 s10, s5, 4
    s_add_u32 s10, s10, s9
    v_mov_b32 v18, 0
    s_mov_b64 exec, 1
    buffer_store_dwordx4 v[64:67], v18, s[52:55], s10 offen sc1
    s_mov_b64 exec, -1
    s_mov_b32 s60, 0
    s_mov_b64 exec, 1
Lp_106:
    ds_read_b128 v[24:27], v2 offset:32
    s_waitcnt lgkmcnt(0)
    v_min_u32 v24, v24, v25
    v_min3_u32 v24, v24, v26, v27
    s_nop 0
    v_readfirstlane_b32 s62, v24
    s_cmp_ge_u32 s62, 4
    s_cbranch_scc1 Ld_107
    s_sleep 4
    s_add_u32 s60, s60, 1
    s_cmp_lt_u32 s60, 4194304
    s_cbranch_scc1 Lp_106
    s_mov_b32 s61, 835
    s_branch L_fail
Ld_107:
    s_mov_b64 exec, -1
    v_and_b32 v18, 31, v0
    v_lshlrev_b32 v18, 4, v18
    s_mov_b32 s60, 0
    s_nop 0
Lg_108:
    buffer_load_dwordx4 v[64:67], v18, s[52:55], s9 offen sc1
    s_waitcnt vmcnt(0)
    v_xor_b32 v64, v14, v64
    v_xor_b32 v65, v14, v65
    v_xor_b32 v66, v14, v66
    v_xor_b32 v67, v14, v67
    v_or3_b32 v41, v64, v65, v66
    v_or_b32 v41, v67, v41
    v_and_b32 v41, 1023, v41
    v_cmp_ne_u32 vcc, 0, v41
    s_cmp_eq_u64 vcc, 0
    s_cbranch_scc1 Ld_109
    s_mov_b64 exec, vcc
    s_sleep 8
    s_add_u32 s60, s60, 1
    s_cmp_lt_u32 s60, 1048576
    s_cbranch_scc1 Lg_108
    s_mov_b64 exec, -1
    s_mov_b32 s61, 836
    s_branch L_fail
Ld_109:
    s_mov_b64 exec, -1
    v_cmp_ne_u32 vcc, s12, v64
    s_cmp_eq_u64 vcc, 0
    s_cselect_b32 s9, 1, 2
    v_mov_b32 v18, s9
    s_mov_b64 exec, 1
    ds_write_b32 v2, v18 offset:52
    s_mov_b64 exec, -1
L_wo:
    s_lshl_b32 s9, s4, 2
    s_add_u32 s15, s9, s6
    v_lshrrev_b32 v12, 3, v0
    v_lshlrev_b32 v12, 9, v12
    v_and_b32 v18, 7, v0
    v_lshl_add_u32 v12, v18, 4, v12
    s_lshl_b32 s9, s15, 14
    s_lshl_b32 s10, s3, 7
    s_add_u32 s9, s9, s10
    s_add_u32 s13, s9, 720896
    s_add_u32 s93, s13, 4096
    s_add_u32 s94, s13, 8192
    s_add_u32 s95, s13, 12288
    v_lshrrev_b32 v18, 1, v5
    v_lshlrev_b32 v15, 12, v18
    v_lshl_add_u32 v15, v6, 5, v15
    v_and_b32 v18, 1, v5
    v_lshl_add_u32 v15, v18, 4, v15
    s_lshl_b32 s10, s7, 15
    s_lshl_b32 s11, s15, 7
    s_add_u32 s10, s10, s11
    s_lshl_b32 s11, s3, 13
    s_add_u32 s10, s10, s11
    s_add_u32 s14, s10, 2097152
    s_lshl_b32 s9, s3, 8
    s_add_u32 s9, s9, 155648
    v_lshrrev_b32 v105, 5, v0
    v_bfe_u32 v10, v0, 4, 1
    v_lshl_add_u32 v105, v10, 1, v105
    v_lshlrev_b32 v105, 6, v105
    v_and_b32 v10, 7, v0
    v_lshl_add_u32 v105, v10, 3, v105
    v_add_u32 v105, s9, v105
    v_lshlrev_b32 v104, 6, v6
    v_lshl_add_u32 v104, v5, 4, v104
    v_add_u32 v104, 155648, v104
    v_lshrrev_b32 v10, 3, v0
    v_lshlrev_b32 v10, 2, v10
    v_add_u32 v10, 161280, v10
    s_mov_b32 s60, 0
    s_mov_b64 exec, 1
Lp_110:
    ds_read_b128 v[24:27], v2 offset:32
    s_waitcnt lgkmcnt(0)
    v_min_u32 v24, v24, v25
    v_min3_u32 v24, v24, v26, v27
    s_nop 0
    v_readfirstlane_b32 s62, v24
    s_cmp_ge_u32 s62, 13
    s_cbranch_scc1 Ld_111
    s_sleep 4
    s_add_u32 s60, s60, 1
    s_cmp_lt_u32 s60, 4194304
    s_cbranch_scc1 Lp_110
    s_mov_b32 s61, 854
    s_branch L_fail
Ld_111:
    s_mov_b64 exec, -1
    s_mov_b32 s60, 0
    s_mov_b64 exec, 1
Lw_112:
    ds_read_b32 v24, v2 offset:28
    s_waitcnt lgkmcnt(0)
    v_readfirstlane_b32 s62, v24
    s_cmp_ge_u32 s62, 1
    s_cbranch_scc1 Ld_113
    s_sleep 1
    s_add_u32 s60, s60, 1
    s_cmp_lt_u32 s60, 4194304
    s_cbranch_scc1 Lw_112
    s_mov_b32 s61, 855
    s_branch L_fail
Ld_113:
    s_mov_b64 exec, -1
    ds_read2_b32 v[96:97], v10 offset0:0 offset1:8
    ds_read2_b32 v[98:99], v10 offset0:16 offset1:24
    s_mov_b32 s60, 0
    s_mov_b64 exec, 1
Lp_114:
    ds_read_b128 v[36:39], v2 offset:32
    s_waitcnt lgkmcnt(0)
    v_min_u32 v36, v36, v37
    v_min3_u32 v36, v36, v38, v39
    s_nop 0
    v_readfirstlane_b32 s62, v36
    s_cmp_ge_u32 s62, 16
    s_cbranch_scc1 Ld_115
    s_sleep 1
    s_add_u32 s60, s60, 1
    s_cmp_lt_u32 s60, 4194304
    s_cbranch_scc1 Lp_114
    s_mov_b32 s61, 856
    s_branch L_fail
Ld_115:
    s_mov_b64 exec, -1
    s_mov_b32 s60, 0
    s_mov_b64 exec, 1
Lw_116:
    ds_read_b32 v36, v2 offset:48
    s_waitcnt lgkmcnt(0)
    v_readfirstlane_b32 s62, v36
    s_cmp_ge_u32 s62, 8
    s_cbranch_scc1 Ld_117
    s_add_u32 s60, s60, 1
    s_cmp_lt_u32 s60, 4194304
    s_nop 0
    s_cbranch_scc1 Lw_116
    s_mov_b32 s61, 850
    s_branch L_fail
Ld_117:
    s_mov_b64 exec, -1
    buffer_load_dwordx4 v[16:19], v12, s[52:55], s13 offen sc1
    buffer_load_dwordx4 v[20:23], v12, s[52:55], s93 offen sc1
    buffer_load_dwordx4 v[24:27], v12, s[52:55], s94 offen sc1
    buffer_load_dwordx4 v[28:31], v12, s[52:55], s95 offen sc1
    s_mov_b32 s60, 0
    s_mov_b64 exec, 1
Lp_118:
    ds_read_b128 v[36:39], v2 offset:32
    s_waitcnt lgkmcnt(0)
    v_min_u32 v36, v36, v37
    v_min3_u32 v36, v36, v38, v39
    s_nop 0
    v_readfirstlane_b32 s62, v36
    s_cmp_ge_u32 s62, 17
    s_cbranch_scc1 Ld_119
    s_add_u32 s60, s60, 1
    s_cmp_lt_u32 s60, 4194304
    s_nop 0
    s_cbranch_scc1 Lp_118
    s_mov_b32 s61, 848
    s_branch L_fail
Ld_119:
    s_mov_b64 exec, -1
    ds_read_b64_tr_b16 v[64:65], v13 offset:0
    ds_read_b64_tr_b16 v[66:67], v13 offset:512
    ds_read_b64_tr_b16 v[68:69], v13 offset:4096
    ds_read_b64_tr_b16 v[70:71], v13 offset:4608
    ds_read_b64_tr_b16 v[72:73], v13 offset:8192
    ds_read_b64_tr_b16 v[74:75], v13 offset:8704
    ds_read_b64_tr_b16 v[76:77], v13 offset:12288
    ds_read_b64_tr_b16 v[78:79], v13 offset:12800
    s_mov_b32 s60, 0
    s_branch Lgc_122
Lg_120:
    buffer_load_dwordx4 v[16:19], v12, s[52:55], s13 offen sc1
    buffer_load_dwordx4 v[20:23], v12, s[52:55], s93 offen sc1
    buffer_load_dwordx4 v[24:27], v12, s[52:55], s94 offen sc1
    buffer_load_dwordx4 v[28:31], v12, s[52:55], s95 offen sc1
Lgc_122:
    s_waitcnt vmcnt(0)
    v_xor_b32 v16, v14, v16
    v_xor_b32 v17, v14, v17
    v_xor_b32 v18, v14, v18
    v_xor_b32 v19, v14, v19
    v_xor_b32 v20, v14, v20
    v_xor_b32 v21, v14, v21
    v_xor_b32 v22, v14, v22
    v_xor_b32 v23, v14, v23
    v_xor_b32 v24, v14, v24
    v_xor_b32 v25, v14, v25
    v_xor_b32 v26, v14, v26
    v_xor_b32 v27, v14, v27
    v_xor_b32 v28, v14, v28
    v_xor_b32 v29, v14, v29
    v_xor_b32 v30, v14, v30
    v_xor_b32 v31, v14, v31
    v_or3_b32 v3, v16, v17, v18
    v_or3_b32 v3, v19, v20, v3
    v_or3_b32 v3, v21, v22, v3
    v_or3_b32 v3, v23, v24, v3
    v_or3_b32 v3, v25, v26, v3
    v_or3_b32 v3, v27, v28, v3
    v_or3_b32 v3, v29, v30, v3
    v_or_b32 v3, v31, v3
    v_and_b32 v3, 1023, v3
    v_cmp_ne_u32 vcc, 0, v3
    s_cmp_eq_u64 vcc, 0
    s_cbranch_scc1 Ld_121
    s_mov_b64 exec, vcc
    s_add_u32 s60, s60, 1
    s_cmp_lt_u32 s60, 1048576
    s_cbranch_scc1 Lg_120
    s_mov_b64 exec, -1
    s_mov_b32 s61, 849
    s_branch L_fail
Ld_121:
    s_mov_b64 exec, -1
    v_pk_mul_f32 v[16:17], v[16:17], v[96:97] op_sel_hi:[1,0]
    v_pk_mul_f32 v[18:19], v[18:19], v[96:97] op_sel_hi:[1,0]
    v_pk_mul_f32 v[20:21], v[20:21], v[96:97] op_sel:[0,1] op_sel_hi:[1,1]
    v_pk_mul_f32 v[22:23], v[22:23], v[96:97] op_sel:[0,1] op_sel_hi:[1,1]
    v_pk_mul_f32 v[24:25], v[24:25], v[98:99] op_sel_hi:[1,0]
    v_pk_mul_f32 v[26:27], v[26:27], v[98:99] op_sel_hi:[1,0]
    v_pk_mul_f32 v[28:29], v[28:29], v[98:99] op_sel:[0,1] op_sel_hi:[1,1]
    v_pk_mul_f32 v[30:31], v[30:31], v[98:99] op_sel:[0,1] op_sel_hi:[1,1]
    v_permlane32_swap_b32 v16, v20
    v_permlane32_swap_b32 v24, v28
    v_permlane32_swap_b32 v17, v21
    v_permlane32_swap_b32 v25, v29
    v_permlane32_swap_b32 v18, v22
    v_permlane32_swap_b32 v26, v30
    v_permlane32_swap_b32 v19, v23
    v_permlane32_swap_b32 v27, v31
    v_pk_add_f32 v[16:17], v[16:17], v[20:21]
    v_pk_add_f32 v[24:25], v[24:25], v[28:29]
    v_pk_add_f32 v[18:19], v[18:19], v[22:23]
    v_pk_add_f32 v[26:27], v[26:27], v[30:31]
    v_permlane16_swap_b32 v16, v24
    v_permlane16_swap_b32 v17, v25
    v_permlane16_swap_b32 v18, v26
    v_permlane16_swap_b32 v19, v27
    v_pk_add_f32 v[16:17], v[16:17], v[24:25]
    v_pk_add_f32 v[18:19], v[18:19], v[26:27]
    s_nop 0
    v_add_f32_dpp v16, v16, v16 row_ror:8 row_mask:0xf bank_mask:0xf
    v_add_f32_dpp v17, v17, v17 row_ror:8 row_mask:0xf bank_mask:0xf
    v_add_f32_dpp v18, v18, v18 row_ror:8 row_mask:0xf bank_mask:0xf
    v_add_f32_dpp v19, v19, v19 row_ror:8 row_mask:0xf bank_mask:0xf
    v_cvt_pk_bf16_f32 v8, v16, v17
    v_cvt_pk_bf16_f32 v9, v18, v19
    ds_write_b64 v105, v[8:9]
    s_mov_b64 exec, 1
    ds_add_u32 v2, v1 offset:64
    s_mov_b64 exec, -1
    s_mov_b32 s60, 0
    s_mov_b64 exec, 1
Lw_123:
    ds_read_b32 v24, v2 offset:64
    s_waitcnt lgkmcnt(0)
    v_readfirstlane_b32 s62, v24
    s_cmp_ge_u32 s62, 4
    s_cbranch_scc1 Ld_124
    s_add_u32 s60, s60, 1
    s_cmp_lt_u32 s60, 4194304
    s_nop 0
    s_cbranch_scc1 Lw_123
    s_mov_b32 s61, 851
    s_branch L_fail
Ld_124:
    s_mov_b64 exec, -1
    ds_read_b128 v[48:51], v104 offset:0
    ds_read_b128 v[52:55], v104 offset:256
    ds_read_b128 v[56:59], v104 offset:512
    ds_read_b128 v[60:63], v104 offset:768
    s_waitcnt lgkmcnt(3)
    v_mfma_f32_16x16x32_bf16 v[32:35], v[64:67], v[48:51], 0
    s_waitcnt lgkmcnt(2)
    v_mfma_f32_16x16x32_bf16 v[32:35], v[68:71], v[52:55], v[32:35]
    s_waitcnt lgkmcnt(1)
    v_mfma_f32_16x16x32_bf16 v[32:35], v[72:75], v[56:59], v[32:35]
    s_waitcnt lgkmcnt(0)
    v_mfma_f32_16x16x32_bf16 v[32:35], v[76:79], v[60:63], v[32:35]
    s_nop 7
    v_and_or_b32 v32, v32, s58, v14
    v_and_or_b32 v33, v33, s58, v14
    v_and_or_b32 v34, v34, s58, v14
    v_and_or_b32 v35, v35, s58, v14
    s_mov_b32 exec_lo, 0x11111111
    s_mov_b32 exec_hi, 0x11111111
    buffer_store_dwordx4 v[32:35], v15, s[52:55], s14 offen sc1
    s_mov_b64 exec, 1
    ds_add_u32 v2, v1 offset:76
    s_mov_b64 exec, -1
    s_endpgm
L_fail:
    v_mov_b32 v4, s61
    s_lshl_b32 s9, s3, 2
    v_mov_b32 v5, s9
    s_mov_b64 exec, 1
    global_store_dword v5, v4, s[34:35]
L_exit:
    s_endpgm
L_code_end:
.section .rodata,"a"
.p2align 6
.amdhsa_kernel recurrent_scan__sliding_block_cached__dense_activation_relu__decode_kernel
  .amdhsa_next_free_vgpr 128
  .amdhsa_next_free_sgpr 102
  .amdhsa_accum_offset 128
  .amdhsa_group_segment_fixed_size 0
  .amdhsa_kernarg_size 88
  .amdhsa_user_sgpr_count 2
  .amdhsa_user_sgpr_kernarg_segment_ptr 1
  .amdhsa_system_sgpr_workgroup_id_x 1
.end_amdhsa_kernel
```
